```python
import torch

def _softmax(x, axis=-1):
    return torch.softmax(x, dim=axis)
def _gelu(x):
    return torch.nn.functional.gelu(x, approximate="tanh")
def _silu(x):
    return torch.nn.functional.silu(x)
def _sigmoid(x):
    return torch.sigmoid(x)
def _layernorm(x, axis=-1, eps=1e-5):
    m = x.mean(dim=axis, keepdim=True)
    v = x.var(dim=axis, keepdim=True, unbiased=False)
    return (x - m) / torch.sqrt(v + eps)
def _scatter_add(tgt, idx, src, axis=0):
    return tgt.clone().index_add_(axis, idx, src)
def _segment_sum(src, seg, n):
    out = torch.zeros((n,) + src.shape[1:], dtype=src.dtype)
    return out.index_add_(0, seg, src)
def _pad(x, pw):
    flat = tuple(v for pair in reversed(pw) for v in pair)
    return torch.nn.functional.pad(x, flat)

kernel_name = 'standalone__sparse_matmul_formats_ell__sparse_mat'

def setup_inputs():

    _w = (lambda a: (lambda t: t.to(torch.bfloat16) if t.is_floating_point() else t)(torch.as_tensor(a)))
    M = N = 16384
    D = 256
    K = max(1, int(0.01 * N))
    col_idx = (lambda lo, hi, *s: torch.randint(lo, hi, s))(0, N, M, K)
    vals = (lambda *s: torch.randn(*s, dtype=torch.bfloat16) * 0.05)(M, K)
    lengths = (lambda lo, hi, *s: torch.randint(lo, hi, s))(1, K + 1, M)
    mask = (torch.arange(K)[None, :] < lengths[:, None]).to(vals.dtype)
    vals = vals * mask
    b = (lambda *s: torch.randn(*s, dtype=torch.bfloat16) * 0.05)(N, D)
    return {
        "vals": _w(vals),
        "col_idx": _w(col_idx),
        "b": _w(b),
    }

def reference(vals, col_idx, b):
    gathered = b[col_idx]
    return torch.einsum("mk,mkd->md", vals, gathered)
```

```asm
; @launch kernel=pre_kernel grid=(1024,1,1) block=(256,1,1) lds=16384
; @launch kernel=standalone__sparse_matmul_formats_ell__sparse_mat_kernel grid=(256,1,1) block=(1024,1,1) lds=163840
.amdgcn_target "amdgcn-amd-amdhsa--gfx950"
.text
.globl standalone__sparse_matmul_formats_ell__sparse_mat_kernel
.p2align 8
.type standalone__sparse_matmul_formats_ell__sparse_mat_kernel,@function
standalone__sparse_matmul_formats_ell__sparse_mat_kernel:
  s_cmp_ge_u32 s2, 256
  s_cbranch_scc1 L_end
  s_load_dwordx2 s[34:35], s[0:1], 24
  s_load_dwordx2 s[36:37], s[0:1], 40
  v_lshrrev_b32 v71, 6, v0
  v_and_b32 v67, 63, v0
  v_readfirstlane_b32 s29, v71
  s_and_b32 s27, s2, 3
  s_lshl_b32 s27, s27, 1
  s_bfe_u32 s3, s2, 0x10003
  s_add_u32 s27, s27, s3
  s_bfe_u32 s28, s2, 0x10002
  s_lshl_b32 s28, s28, 4
  s_lshr_b32 s3, s2, 4
  s_add_u32 s28, s28, s3
  s_lshl_b32 s28, s28, 5
  s_add_u32 s28, s28, s29
  s_mul_i32 s17, s28, 9984
  s_lshl_b32 s26, s28, 6
  s_add_u32 s26, s26, 251658240
  v_lshrrev_b32 v71, 4, v67
  v_mul_u32_u24 v71, 704, v71
  v_lshl_add_u32 v71, v67, 2, v71
  v_mul_u32_u24 v59, 12, v67
  v_and_b32 v55, 3, v67
  v_lshlrev_b32 v55, 3, v55
  s_lshr_b32 s3, s29, 3
  s_mul_i32 s3, s3, 8192
  s_lshl_b32 s19, s29, 12
  s_add_u32 s19, s19, s3
  s_add_u32 s19, s19, 8192
  v_lshlrev_b32 v75, 4, v67
  s_mul_i32 s18, s27, 1064960
  s_add_u32 s18, s18, 234881024
  s_add_u32 s3, s18, s19
  s_waitcnt lgkmcnt(0)
  s_mov_b32 s4, s36
  s_mov_b32 s5, s37
  s_mov_b32 s6, 0x10000000
  s_mov_b32 s7, 0x20000
  s_mov_b32 s8, s34
  s_mov_b32 s9, s35
  s_mov_b32 s10, 0x800000
  s_mov_b32 s11, 0x20000
  s_mov_b32 m0, s19
  s_add_u32 s25, s3, 4096
  buffer_load_dwordx4 v75, s[4:7], s3 offen offset:0 lds
  buffer_load_dwordx4 v75, s[4:7], s3 offen offset:1024 lds
  buffer_load_dwordx4 v75, s[4:7], s3 offen offset:2048 lds
  buffer_load_dwordx4 v75, s[4:7], s3 offen offset:3072 lds
  s_add_u32 m0, s19, 4096
  s_cmp_lt_u32 s29, 12
  s_cbranch_scc1 L_comp
  s_sub_u32 s29, s29, 12
  s_mul_i32 s19, s29, 20480
  s_add_u32 s18, s18, s19
  s_add_u32 s30, s19, 81920
  s_xor_b32 s30, s30, s19
  s_mov_b32 s16, 1
  s_waitcnt vmcnt(0)
  s_barrier
L_load:
  s_xor_b32 s19, s19, s30
  s_add_u32 s18, s18, 81920
  s_add_u32 m0, s19, 0
  s_add_u32 s25, s18, 0
  buffer_load_dwordx4 v75, s[4:7], s25 offen offset:0 lds
  buffer_load_dwordx4 v75, s[4:7], s25 offen offset:1024 lds
  buffer_load_dwordx4 v75, s[4:7], s25 offen offset:2048 lds
  buffer_load_dwordx4 v75, s[4:7], s25 offen offset:3072 lds
  s_add_u32 m0, s19, 4096
  s_add_u32 s25, s18, 4096
  buffer_load_dwordx4 v75, s[4:7], s25 offen offset:0 lds
  buffer_load_dwordx4 v75, s[4:7], s25 offen offset:1024 lds
  buffer_load_dwordx4 v75, s[4:7], s25 offen offset:2048 lds
  buffer_load_dwordx4 v75, s[4:7], s25 offen offset:3072 lds
  s_add_u32 m0, s19, 8192
  s_add_u32 s25, s18, 8192
  buffer_load_dwordx4 v75, s[4:7], s25 offen offset:0 lds
  buffer_load_dwordx4 v75, s[4:7], s25 offen offset:1024 lds
  buffer_load_dwordx4 v75, s[4:7], s25 offen offset:2048 lds
  buffer_load_dwordx4 v75, s[4:7], s25 offen offset:3072 lds
  s_add_u32 m0, s19, 12288
  s_add_u32 s25, s18, 12288
  buffer_load_dwordx4 v75, s[4:7], s25 offen offset:0 lds
  buffer_load_dwordx4 v75, s[4:7], s25 offen offset:1024 lds
  buffer_load_dwordx4 v75, s[4:7], s25 offen offset:2048 lds
  buffer_load_dwordx4 v75, s[4:7], s25 offen offset:3072 lds
  s_add_u32 m0, s19, 16384
  s_add_u32 s25, s18, 16384
  buffer_load_dwordx4 v75, s[4:7], s25 offen offset:0 lds
  buffer_load_dwordx4 v75, s[4:7], s25 offen offset:1024 lds
  buffer_load_dwordx4 v75, s[4:7], s25 offen offset:2048 lds
  buffer_load_dwordx4 v75, s[4:7], s25 offen offset:3072 lds
  s_add_u32 s16, s16, 1
  s_cmp_lt_u32 s16, 13
  s_waitcnt vmcnt(0)
  s_barrier
  s_cbranch_scc1 L_load
  s_branch L_fin
L_comp:
  s_setprio 1
  buffer_load_dword v63, v71, s[4:7], s26 offen
  s_mov_b32 s16, 0
  s_add_u32 s25, s17, 0
  buffer_load_dwordx3 v[40:42], v59, s[4:7], s25 offen
  s_add_u32 s25, s25, 10223616
  buffer_load_dwordx3 v[64:66], v59, s[4:7], s25 offen
L_nsa0:
  s_add_u32 s25, s17, 119808
  buffer_load_dwordx3 v[44:46], v59, s[4:7], s25 offen
  s_add_u32 s25, s25, 10223616
  buffer_load_dwordx3 v[68:70], v59, s[4:7], s25 offen
L_nsb0:
  s_cmp_ge_u32 s29, 8
  s_cbranch_scc1 L_noc0
  s_add_u32 s25, s17, 239616
  buffer_load_dwordx3 v[48:50], v59, s[4:7], s25 offen
  s_add_u32 s25, s25, 10223616
  buffer_load_dwordx3 v[72:74], v59, s[4:7], s25 offen
L_nsc0:
L_noc0:
  s_add_u32 s17, s17, 768
  v_mov_b32 v4, 0
  v_mov_b32 v5, 0
  v_mov_b32 v6, 0
  v_mov_b32 v7, 0
  v_mov_b32 v8, 0
  v_mov_b32 v9, 0
  v_mov_b32 v10, 0
  v_mov_b32 v11, 0
  v_mov_b32 v12, 0
  v_mov_b32 v13, 0
  v_mov_b32 v14, 0
  v_mov_b32 v15, 0
  v_mov_b32 v16, 0
  v_mov_b32 v17, 0
  v_mov_b32 v18, 0
  v_mov_b32 v19, 0
  v_mov_b32 v20, 0
  v_mov_b32 v21, 0
  v_mov_b32 v22, 0
  v_mov_b32 v23, 0
  v_mov_b32 v24, 0
  v_mov_b32 v25, 0
  v_mov_b32 v26, 0
  v_mov_b32 v27, 0
  s_cmp_ge_u32 s29, 8
  s_cselect_b32 s47, 0, 4
  s_cselect_b32 s3, 32, 64
  v_cmp_gt_u32 vcc, s3, v67
  s_waitcnt vmcnt(0)
  s_nop 0
  v_cndmask_b32 v63, 0, v63, vcc
  v_min_u32 v63, 168, v63
  s_nop 1
  v_readlane_b32 s44, v63, 0
  v_readlane_b32 s45, v63, 16
  v_readlane_b32 s46, v63, 32
  s_sub_u32 s17, s17, 768
  s_mov_b32 s22, 0
  s_add_u32 s26, s16, 1
  s_add_u32 s25, s17, 768
  v_readlane_b32 s20, v63, s26
  buffer_load_dwordx3 v[28:30], v59, s[4:7], s25 offen
  s_cmp_le_u32 s20, 8
  s_cbranch_scc1 L_nfpa
  s_add_u32 s25, s25, 10223616
  buffer_load_dwordx3 v[52:54], v59, s[4:7], s25 offen
L_nfpa:
  s_add_u32 s26, s16, 17
  s_add_u32 s25, s17, 120576
  v_readlane_b32 s21, v63, s26
  buffer_load_dwordx3 v[32:34], v59, s[4:7], s25 offen
  s_cmp_le_u32 s21, 8
  s_cbranch_scc1 L_nfpb
  s_add_u32 s25, s25, 10223616
  buffer_load_dwordx3 v[56:58], v59, s[4:7], s25 offen
L_nfpb:
  s_cmp_ge_u32 s29, 8
  s_cbranch_scc1 L_nfpc
  s_add_u32 s26, s16, 33
  s_add_u32 s25, s17, 240384
  v_readlane_b32 s22, v63, s26
  buffer_load_dwordx3 v[36:38], v59, s[4:7], s25 offen
  s_cmp_le_u32 s22, 8
  s_cbranch_scc1 L_nfpc
  s_add_u32 s25, s25, 10223616
  buffer_load_dwordx3 v[60:62], v59, s[4:7], s25 offen
L_nfpc:
  s_barrier
L_phase0:
  s_setprio 3
  s_mov_b32 s24, 0
L_blkc0:
  s_cmp_ge_u32 s46, 8
  s_cbranch_scc1 L_v4c0
  s_cmp_eq_u32 s46, 7
  s_cbranch_scc1 L_w7c0
  s_cmp_eq_u32 s46, 6
  s_cbranch_scc1 L_w6c0
  s_cmp_eq_u32 s46, 5
  s_cbranch_scc1 L_w5c0
  s_cmp_eq_u32 s46, 4
  s_cbranch_scc1 L_w4c0
  s_cmp_eq_u32 s46, 3
  s_cbranch_scc1 L_w3c0
  s_cmp_eq_u32 s46, 2
  s_cbranch_scc1 L_w2c0
  s_cmp_eq_u32 s46, 0
  s_cbranch_scc1 L_donec0
L_w1c0:
  v_and_b32 v120, 0xffff, v48
  v_lshlrev_b32 v51, 8, v50
  s_nop 0
  v_add_u32_dpp v76, v120, v55 quad_perm:[0,0,0,0] row_mask:0xf bank_mask:0xf
  ds_read_b64_tr_b16 v[84:85], v76 offset:0
  ds_read_b64_tr_b16 v[88:89], v76 offset:40960
  v_pk_ashrrev_i16 v120, 15, v50 op_sel_hi:[0,1]
  v_pk_ashrrev_i16 v121, 15, v51 op_sel_hi:[0,1]
  v_and_b32_dpp v76, v49, v120 row_newbcast:0 row_mask:0xf bank_mask:0xf
  v_and_b32_dpp v77, v49, v121 row_newbcast:1 row_mask:0xf bank_mask:0xf
  s_waitcnt lgkmcnt(1)
  s_nop 0
  v_mfma_f32_16x16x16_bf16 v[20:23], v[84:85], v[76:77], v[20:23]
  s_waitcnt lgkmcnt(0)
  v_mfma_f32_16x16x16_bf16 v[24:27], v[88:89], v[76:77], v[24:27]
  s_branch L_donec0
L_w2c0:
  v_lshrrev_b32 v121, 16, v48
  v_and_b32 v120, 0xffff, v48
  v_lshlrev_b32 v51, 8, v50
  s_nop 0
  v_add_u32_dpp v76, v120, v55 quad_perm:[0,0,0,0] row_mask:0xf bank_mask:0xf
  v_add_u32_dpp v77, v121, v55 quad_perm:[0,0,0,0] row_mask:0xf bank_mask:0xf
  ds_read_b64_tr_b16 v[84:85], v76 offset:0
  ds_read_b64_tr_b16 v[86:87], v77 offset:0
  ds_read_b64_tr_b16 v[88:89], v76 offset:40960
  ds_read_b64_tr_b16 v[90:91], v77 offset:40960
  v_lshlrev_b64 v[118:119], 1, v[50:51]
  v_pk_ashrrev_i16 v120, 15, v50 op_sel_hi:[0,1]
  v_pk_ashrrev_i16 v121, 15, v51 op_sel_hi:[0,1]
  v_pk_ashrrev_i16 v122, 15, v118 op_sel_hi:[0,1]
  v_pk_ashrrev_i16 v123, 15, v119 op_sel_hi:[0,1]
  v_and_b32_dpp v76, v49, v120 row_newbcast:0 row_mask:0xf bank_mask:0xf
  v_and_b32_dpp v77, v49, v121 row_newbcast:1 row_mask:0xf bank_mask:0xf
  v_and_b32_dpp v78, v49, v122 row_newbcast:2 row_mask:0xf bank_mask:0xf
  v_and_b32_dpp v79, v49, v123 row_newbcast:3 row_mask:0xf bank_mask:0xf
  s_waitcnt lgkmcnt(2)
  s_nop 0
  v_mfma_f32_16x16x32_bf16 v[20:23], v[84:87], v[76:79], v[20:23]
  s_waitcnt lgkmcnt(0)
  v_mfma_f32_16x16x32_bf16 v[24:27], v[88:91], v[76:79], v[24:27]
  s_branch L_donec0
L_w3c0:
  v_lshrrev_b32 v121, 16, v48
  v_and_b32 v120, 0xffff, v48
  v_lshlrev_b32 v51, 8, v50
  s_nop 0
  v_add_u32_dpp v76, v120, v55 quad_perm:[0,0,0,0] row_mask:0xf bank_mask:0xf
  v_add_u32_dpp v77, v121, v55 quad_perm:[0,0,0,0] row_mask:0xf bank_mask:0xf
  ds_read_b64_tr_b16 v[84:85], v76 offset:0
  ds_read_b64_tr_b16 v[86:87], v77 offset:0
  ds_read_b64_tr_b16 v[88:89], v76 offset:40960
  ds_read_b64_tr_b16 v[90:91], v77 offset:40960
  v_add_u32_dpp v78, v120, v55 quad_perm:[1,1,1,1] row_mask:0xf bank_mask:0xf
  ds_read_b64_tr_b16 v[92:93], v78 offset:0
  ds_read_b64_tr_b16 v[96:97], v78 offset:40960
  v_lshlrev_b64 v[118:119], 1, v[50:51]
  v_pk_ashrrev_i16 v120, 15, v50 op_sel_hi:[0,1]
  v_pk_ashrrev_i16 v121, 15, v51 op_sel_hi:[0,1]
  v_pk_ashrrev_i16 v122, 15, v118 op_sel_hi:[0,1]
  v_pk_ashrrev_i16 v123, 15, v119 op_sel_hi:[0,1]
  v_and_b32_dpp v76, v49, v120 row_newbcast:0 row_mask:0xf bank_mask:0xf
  v_and_b32_dpp v77, v49, v121 row_newbcast:1 row_mask:0xf bank_mask:0xf
  v_and_b32_dpp v78, v49, v122 row_newbcast:2 row_mask:0xf bank_mask:0xf
  v_and_b32_dpp v79, v49, v123 row_newbcast:3 row_mask:0xf bank_mask:0xf
  v_lshlrev_b64 v[116:117], 2, v[50:51]
  v_pk_ashrrev_i16 v120, 15, v116 op_sel_hi:[0,1]
  v_pk_ashrrev_i16 v121, 15, v117 op_sel_hi:[0,1]
  s_waitcnt lgkmcnt(4)
  v_mfma_f32_16x16x32_bf16 v[20:23], v[84:87], v[76:79], v[20:23]
  v_and_b32_dpp v80, v49, v120 row_newbcast:4 row_mask:0xf bank_mask:0xf
  v_and_b32_dpp v81, v49, v121 row_newbcast:5 row_mask:0xf bank_mask:0xf
  s_waitcnt lgkmcnt(2)
  v_mfma_f32_16x16x32_bf16 v[24:27], v[88:91], v[76:79], v[24:27]
  s_waitcnt lgkmcnt(1)
  s_nop 0
  v_mfma_f32_16x16x16_bf16 v[20:23], v[92:93], v[80:81], v[20:23]
  s_waitcnt lgkmcnt(0)
  v_mfma_f32_16x16x16_bf16 v[24:27], v[96:97], v[80:81], v[24:27]
  s_branch L_donec0
L_w4c0:
  v_lshrrev_b32 v121, 16, v48
  v_and_b32 v120, 0xffff, v48
  v_lshlrev_b32 v51, 8, v50
  s_nop 0
  v_add_u32_dpp v76, v120, v55 quad_perm:[0,0,0,0] row_mask:0xf bank_mask:0xf
  v_add_u32_dpp v77, v121, v55 quad_perm:[0,0,0,0] row_mask:0xf bank_mask:0xf
  ds_read_b64_tr_b16 v[84:85], v76 offset:0
  ds_read_b64_tr_b16 v[86:87], v77 offset:0
  ds_read_b64_tr_b16 v[88:89], v76 offset:40960
  ds_read_b64_tr_b16 v[90:91], v77 offset:40960
  v_add_u32_dpp v78, v120, v55 quad_perm:[1,1,1,1] row_mask:0xf bank_mask:0xf
  v_add_u32_dpp v79, v121, v55 quad_perm:[1,1,1,1] row_mask:0xf bank_mask:0xf
  ds_read_b64_tr_b16 v[92:93], v78 offset:0
  ds_read_b64_tr_b16 v[94:95], v79 offset:0
  ds_read_b64_tr_b16 v[96:97], v78 offset:40960
  ds_read_b64_tr_b16 v[98:99], v79 offset:40960
  v_lshlrev_b64 v[118:119], 1, v[50:51]
  v_pk_ashrrev_i16 v120, 15, v50 op_sel_hi:[0,1]
  v_pk_ashrrev_i16 v121, 15, v51 op_sel_hi:[0,1]
  v_pk_ashrrev_i16 v122, 15, v118 op_sel_hi:[0,1]
  v_pk_ashrrev_i16 v123, 15, v119 op_sel_hi:[0,1]
  v_and_b32_dpp v76, v49, v120 row_newbcast:0 row_mask:0xf bank_mask:0xf
  v_and_b32_dpp v77, v49, v121 row_newbcast:1 row_mask:0xf bank_mask:0xf
  v_and_b32_dpp v78, v49, v122 row_newbcast:2 row_mask:0xf bank_mask:0xf
  v_and_b32_dpp v79, v49, v123 row_newbcast:3 row_mask:0xf bank_mask:0xf
  v_lshlrev_b64 v[116:117], 2, v[50:51]
  v_lshlrev_b64 v[118:119], 3, v[50:51]
  v_pk_ashrrev_i16 v120, 15, v116 op_sel_hi:[0,1]
  v_pk_ashrrev_i16 v121, 15, v117 op_sel_hi:[0,1]
  v_pk_ashrrev_i16 v122, 15, v118 op_sel_hi:[0,1]
  s_waitcnt lgkmcnt(6)
  v_mfma_f32_16x16x32_bf16 v[20:23], v[84:87], v[76:79], v[20:23]
  v_pk_ashrrev_i16 v123, 15, v119 op_sel_hi:[0,1]
  v_and_b32_dpp v80, v49, v120 row_newbcast:4 row_mask:0xf bank_mask:0xf
  v_and_b32_dpp v81, v49, v121 row_newbcast:5 row_mask:0xf bank_mask:0xf
  v_and_b32_dpp v82, v49, v122 row_newbcast:6 row_mask:0xf bank_mask:0xf
  v_and_b32_dpp v83, v49, v123 row_newbcast:7 row_mask:0xf bank_mask:0xf
  s_waitcnt lgkmcnt(4)
  v_mfma_f32_16x16x32_bf16 v[24:27], v[88:91], v[76:79], v[24:27]
  s_waitcnt lgkmcnt(2)
  s_nop 0
  v_mfma_f32_16x16x32_bf16 v[20:23], v[92:95], v[80:83], v[20:23]
  s_waitcnt lgkmcnt(0)
  v_mfma_f32_16x16x32_bf16 v[24:27], v[96:99], v[80:83], v[24:27]
  s_branch L_donec0
L_w5c0:
  v_lshrrev_b32 v121, 16, v48
  v_and_b32 v120, 0xffff, v48
  v_lshlrev_b32 v51, 8, v50
  s_nop 0
  v_add_u32_dpp v76, v120, v55 quad_perm:[0,0,0,0] row_mask:0xf bank_mask:0xf
  v_add_u32_dpp v77, v121, v55 quad_perm:[0,0,0,0] row_mask:0xf bank_mask:0xf
  ds_read_b64_tr_b16 v[84:85], v76 offset:0
  ds_read_b64_tr_b16 v[86:87], v77 offset:0
  ds_read_b64_tr_b16 v[88:89], v76 offset:40960
  ds_read_b64_tr_b16 v[90:91], v77 offset:40960
  v_add_u32_dpp v78, v120, v55 quad_perm:[1,1,1,1] row_mask:0xf bank_mask:0xf
  v_add_u32_dpp v79, v121, v55 quad_perm:[1,1,1,1] row_mask:0xf bank_mask:0xf
  ds_read_b64_tr_b16 v[92:93], v78 offset:0
  ds_read_b64_tr_b16 v[94:95], v79 offset:0
  ds_read_b64_tr_b16 v[96:97], v78 offset:40960
  ds_read_b64_tr_b16 v[98:99], v79 offset:40960
  v_add_u32_dpp v80, v120, v55 quad_perm:[2,2,2,2] row_mask:0xf bank_mask:0xf
  ds_read_b64_tr_b16 v[100:101], v80 offset:0
  ds_read_b64_tr_b16 v[104:105], v80 offset:40960
  v_lshlrev_b64 v[118:119], 1, v[50:51]
  v_pk_ashrrev_i16 v120, 15, v50 op_sel_hi:[0,1]
  v_pk_ashrrev_i16 v121, 15, v51 op_sel_hi:[0,1]
  v_pk_ashrrev_i16 v122, 15, v118 op_sel_hi:[0,1]
  v_pk_ashrrev_i16 v123, 15, v119 op_sel_hi:[0,1]
  v_and_b32_dpp v76, v49, v120 row_newbcast:0 row_mask:0xf bank_mask:0xf
  v_and_b32_dpp v77, v49, v121 row_newbcast:1 row_mask:0xf bank_mask:0xf
  v_and_b32_dpp v78, v49, v122 row_newbcast:2 row_mask:0xf bank_mask:0xf
  v_and_b32_dpp v79, v49, v123 row_newbcast:3 row_mask:0xf bank_mask:0xf
  v_lshlrev_b64 v[116:117], 2, v[50:51]
  v_lshlrev_b64 v[118:119], 3, v[50:51]
  v_pk_ashrrev_i16 v120, 15, v116 op_sel_hi:[0,1]
  v_pk_ashrrev_i16 v121, 15, v117 op_sel_hi:[0,1]
  v_pk_ashrrev_i16 v122, 15, v118 op_sel_hi:[0,1]
  s_waitcnt lgkmcnt(8)
  v_mfma_f32_16x16x32_bf16 v[20:23], v[84:87], v[76:79], v[20:23]
  v_pk_ashrrev_i16 v123, 15, v119 op_sel_hi:[0,1]
  v_and_b32_dpp v80, v49, v120 row_newbcast:4 row_mask:0xf bank_mask:0xf
  v_and_b32_dpp v81, v49, v121 row_newbcast:5 row_mask:0xf bank_mask:0xf
  v_and_b32_dpp v82, v49, v122 row_newbcast:6 row_mask:0xf bank_mask:0xf
  v_and_b32_dpp v83, v49, v123 row_newbcast:7 row_mask:0xf bank_mask:0xf
  s_waitcnt lgkmcnt(6)
  v_mfma_f32_16x16x32_bf16 v[24:27], v[88:91], v[76:79], v[24:27]
  v_lshlrev_b64 v[116:117], 4, v[50:51]
  v_pk_ashrrev_i16 v120, 15, v116 op_sel_hi:[0,1]
  v_pk_ashrrev_i16 v121, 15, v117 op_sel_hi:[0,1]
  s_waitcnt lgkmcnt(4)
  v_mfma_f32_16x16x32_bf16 v[20:23], v[92:95], v[80:83], v[20:23]
  v_and_b32_dpp v76, v49, v120 row_newbcast:8 row_mask:0xf bank_mask:0xf
  v_and_b32_dpp v77, v49, v121 row_newbcast:9 row_mask:0xf bank_mask:0xf
  s_waitcnt lgkmcnt(2)
  v_mfma_f32_16x16x32_bf16 v[24:27], v[96:99], v[80:83], v[24:27]
  s_waitcnt lgkmcnt(1)
  s_nop 0
  v_mfma_f32_16x16x16_bf16 v[20:23], v[100:101], v[76:77], v[20:23]
  s_waitcnt lgkmcnt(0)
  v_mfma_f32_16x16x16_bf16 v[24:27], v[104:105], v[76:77], v[24:27]
  s_branch L_donec0
L_w6c0:
  v_lshrrev_b32 v121, 16, v48
  v_and_b32 v120, 0xffff, v48
  v_lshlrev_b32 v51, 8, v50
  s_nop 0
  v_add_u32_dpp v76, v120, v55 quad_perm:[0,0,0,0] row_mask:0xf bank_mask:0xf
  v_add_u32_dpp v77, v121, v55 quad_perm:[0,0,0,0] row_mask:0xf bank_mask:0xf
  ds_read_b64_tr_b16 v[84:85], v76 offset:0
  ds_read_b64_tr_b16 v[86:87], v77 offset:0
  ds_read_b64_tr_b16 v[88:89], v76 offset:40960
  ds_read_b64_tr_b16 v[90:91], v77 offset:40960
  v_add_u32_dpp v78, v120, v55 quad_perm:[1,1,1,1] row_mask:0xf bank_mask:0xf
  v_add_u32_dpp v79, v121, v55 quad_perm:[1,1,1,1] row_mask:0xf bank_mask:0xf
  ds_read_b64_tr_b16 v[92:93], v78 offset:0
  ds_read_b64_tr_b16 v[94:95], v79 offset:0
  ds_read_b64_tr_b16 v[96:97], v78 offset:40960
  ds_read_b64_tr_b16 v[98:99], v79 offset:40960
  v_add_u32_dpp v80, v120, v55 quad_perm:[2,2,2,2] row_mask:0xf bank_mask:0xf
  v_add_u32_dpp v81, v121, v55 quad_perm:[2,2,2,2] row_mask:0xf bank_mask:0xf
  ds_read_b64_tr_b16 v[100:101], v80 offset:0
  ds_read_b64_tr_b16 v[102:103], v81 offset:0
  ds_read_b64_tr_b16 v[104:105], v80 offset:40960
  ds_read_b64_tr_b16 v[106:107], v81 offset:40960
  v_lshlrev_b64 v[118:119], 1, v[50:51]
  v_pk_ashrrev_i16 v120, 15, v50 op_sel_hi:[0,1]
  v_pk_ashrrev_i16 v121, 15, v51 op_sel_hi:[0,1]
  v_pk_ashrrev_i16 v122, 15, v118 op_sel_hi:[0,1]
  v_pk_ashrrev_i16 v123, 15, v119 op_sel_hi:[0,1]
  v_and_b32_dpp v76, v49, v120 row_newbcast:0 row_mask:0xf bank_mask:0xf
  v_and_b32_dpp v77, v49, v121 row_newbcast:1 row_mask:0xf bank_mask:0xf
  v_and_b32_dpp v78, v49, v122 row_newbcast:2 row_mask:0xf bank_mask:0xf
  v_and_b32_dpp v79, v49, v123 row_newbcast:3 row_mask:0xf bank_mask:0xf
  v_lshlrev_b64 v[116:117], 2, v[50:51]
  v_lshlrev_b64 v[118:119], 3, v[50:51]
  v_pk_ashrrev_i16 v120, 15, v116 op_sel_hi:[0,1]
  v_pk_ashrrev_i16 v121, 15, v117 op_sel_hi:[0,1]
  v_pk_ashrrev_i16 v122, 15, v118 op_sel_hi:[0,1]
  s_waitcnt lgkmcnt(10)
  v_mfma_f32_16x16x32_bf16 v[20:23], v[84:87], v[76:79], v[20:23]
  v_pk_ashrrev_i16 v123, 15, v119 op_sel_hi:[0,1]
  v_and_b32_dpp v80, v49, v120 row_newbcast:4 row_mask:0xf bank_mask:0xf
  v_and_b32_dpp v81, v49, v121 row_newbcast:5 row_mask:0xf bank_mask:0xf
  v_and_b32_dpp v82, v49, v122 row_newbcast:6 row_mask:0xf bank_mask:0xf
  v_and_b32_dpp v83, v49, v123 row_newbcast:7 row_mask:0xf bank_mask:0xf
  s_waitcnt lgkmcnt(8)
  v_mfma_f32_16x16x32_bf16 v[24:27], v[88:91], v[76:79], v[24:27]
  v_lshlrev_b64 v[116:117], 4, v[50:51]
  v_lshlrev_b64 v[118:119], 5, v[50:51]
  v_pk_ashrrev_i16 v120, 15, v116 op_sel_hi:[0,1]
  v_pk_ashrrev_i16 v121, 15, v117 op_sel_hi:[0,1]
  v_pk_ashrrev_i16 v122, 15, v118 op_sel_hi:[0,1]
  s_waitcnt lgkmcnt(6)
  v_mfma_f32_16x16x32_bf16 v[20:23], v[92:95], v[80:83], v[20:23]
  v_pk_ashrrev_i16 v123, 15, v119 op_sel_hi:[0,1]
  v_and_b32_dpp v76, v49, v120 row_newbcast:8 row_mask:0xf bank_mask:0xf
  v_and_b32_dpp v77, v49, v121 row_newbcast:9 row_mask:0xf bank_mask:0xf
  v_and_b32_dpp v78, v49, v122 row_newbcast:10 row_mask:0xf bank_mask:0xf
  v_and_b32_dpp v79, v49, v123 row_newbcast:11 row_mask:0xf bank_mask:0xf
  s_waitcnt lgkmcnt(4)
  v_mfma_f32_16x16x32_bf16 v[24:27], v[96:99], v[80:83], v[24:27]
  s_waitcnt lgkmcnt(2)
  s_nop 0
  v_mfma_f32_16x16x32_bf16 v[20:23], v[100:103], v[76:79], v[20:23]
  s_waitcnt lgkmcnt(0)
  v_mfma_f32_16x16x32_bf16 v[24:27], v[104:107], v[76:79], v[24:27]
  s_branch L_donec0
L_w7c0:
  v_lshrrev_b32 v121, 16, v48
  v_and_b32 v120, 0xffff, v48
  v_lshlrev_b32 v51, 8, v50
  s_nop 0
  v_add_u32_dpp v76, v120, v55 quad_perm:[0,0,0,0] row_mask:0xf bank_mask:0xf
  v_add_u32_dpp v77, v121, v55 quad_perm:[0,0,0,0] row_mask:0xf bank_mask:0xf
  ds_read_b64_tr_b16 v[84:85], v76 offset:0
  ds_read_b64_tr_b16 v[86:87], v77 offset:0
  ds_read_b64_tr_b16 v[88:89], v76 offset:40960
  ds_read_b64_tr_b16 v[90:91], v77 offset:40960
  v_add_u32_dpp v78, v120, v55 quad_perm:[1,1,1,1] row_mask:0xf bank_mask:0xf
  v_add_u32_dpp v79, v121, v55 quad_perm:[1,1,1,1] row_mask:0xf bank_mask:0xf
  ds_read_b64_tr_b16 v[92:93], v78 offset:0
  ds_read_b64_tr_b16 v[94:95], v79 offset:0
  ds_read_b64_tr_b16 v[96:97], v78 offset:40960
  ds_read_b64_tr_b16 v[98:99], v79 offset:40960
  v_add_u32_dpp v80, v120, v55 quad_perm:[2,2,2,2] row_mask:0xf bank_mask:0xf
  v_add_u32_dpp v81, v121, v55 quad_perm:[2,2,2,2] row_mask:0xf bank_mask:0xf
  ds_read_b64_tr_b16 v[100:101], v80 offset:0
  ds_read_b64_tr_b16 v[102:103], v81 offset:0
  ds_read_b64_tr_b16 v[104:105], v80 offset:40960
  ds_read_b64_tr_b16 v[106:107], v81 offset:40960
  v_add_u32_dpp v82, v120, v55 quad_perm:[3,3,3,3] row_mask:0xf bank_mask:0xf
  ds_read_b64_tr_b16 v[108:109], v82 offset:0
  ds_read_b64_tr_b16 v[112:113], v82 offset:40960
  v_lshlrev_b64 v[118:119], 1, v[50:51]
  v_pk_ashrrev_i16 v120, 15, v50 op_sel_hi:[0,1]
  v_pk_ashrrev_i16 v121, 15, v51 op_sel_hi:[0,1]
  v_pk_ashrrev_i16 v122, 15, v118 op_sel_hi:[0,1]
  v_pk_ashrrev_i16 v123, 15, v119 op_sel_hi:[0,1]
  v_and_b32_dpp v76, v49, v120 row_newbcast:0 row_mask:0xf bank_mask:0xf
  v_and_b32_dpp v77, v49, v121 row_newbcast:1 row_mask:0xf bank_mask:0xf
  v_and_b32_dpp v78, v49, v122 row_newbcast:2 row_mask:0xf bank_mask:0xf
  v_and_b32_dpp v79, v49, v123 row_newbcast:3 row_mask:0xf bank_mask:0xf
  v_lshlrev_b64 v[116:117], 2, v[50:51]
  v_lshlrev_b64 v[118:119], 3, v[50:51]
  v_pk_ashrrev_i16 v120, 15, v116 op_sel_hi:[0,1]
  v_pk_ashrrev_i16 v121, 15, v117 op_sel_hi:[0,1]
  v_pk_ashrrev_i16 v122, 15, v118 op_sel_hi:[0,1]
  s_waitcnt lgkmcnt(12)
  v_mfma_f32_16x16x32_bf16 v[20:23], v[84:87], v[76:79], v[20:23]
  v_pk_ashrrev_i16 v123, 15, v119 op_sel_hi:[0,1]
  v_and_b32_dpp v80, v49, v120 row_newbcast:4 row_mask:0xf bank_mask:0xf
  v_and_b32_dpp v81, v49, v121 row_newbcast:5 row_mask:0xf bank_mask:0xf
  v_and_b32_dpp v82, v49, v122 row_newbcast:6 row_mask:0xf bank_mask:0xf
  v_and_b32_dpp v83, v49, v123 row_newbcast:7 row_mask:0xf bank_mask:0xf
  s_waitcnt lgkmcnt(10)
  v_mfma_f32_16x16x32_bf16 v[24:27], v[88:91], v[76:79], v[24:27]
  v_lshlrev_b64 v[116:117], 4, v[50:51]
  v_lshlrev_b64 v[118:119], 5, v[50:51]
  v_pk_ashrrev_i16 v120, 15, v116 op_sel_hi:[0,1]
  v_pk_ashrrev_i16 v121, 15, v117 op_sel_hi:[0,1]
  v_pk_ashrrev_i16 v122, 15, v118 op_sel_hi:[0,1]
  s_waitcnt lgkmcnt(8)
  v_mfma_f32_16x16x32_bf16 v[20:23], v[92:95], v[80:83], v[20:23]
  v_pk_ashrrev_i16 v123, 15, v119 op_sel_hi:[0,1]
  v_and_b32_dpp v76, v49, v120 row_newbcast:8 row_mask:0xf bank_mask:0xf
  v_and_b32_dpp v77, v49, v121 row_newbcast:9 row_mask:0xf bank_mask:0xf
  v_and_b32_dpp v78, v49, v122 row_newbcast:10 row_mask:0xf bank_mask:0xf
  v_and_b32_dpp v79, v49, v123 row_newbcast:11 row_mask:0xf bank_mask:0xf
  s_waitcnt lgkmcnt(6)
  v_mfma_f32_16x16x32_bf16 v[24:27], v[96:99], v[80:83], v[24:27]
  v_lshlrev_b64 v[116:117], 6, v[50:51]
  v_pk_ashrrev_i16 v120, 15, v116 op_sel_hi:[0,1]
  v_pk_ashrrev_i16 v121, 15, v117 op_sel_hi:[0,1]
  s_waitcnt lgkmcnt(4)
  v_mfma_f32_16x16x32_bf16 v[20:23], v[100:103], v[76:79], v[20:23]
  v_and_b32_dpp v80, v49, v120 row_newbcast:12 row_mask:0xf bank_mask:0xf
  v_and_b32_dpp v81, v49, v121 row_newbcast:13 row_mask:0xf bank_mask:0xf
  s_waitcnt lgkmcnt(2)
  v_mfma_f32_16x16x32_bf16 v[24:27], v[104:107], v[76:79], v[24:27]
  s_waitcnt lgkmcnt(1)
  s_nop 0
  v_mfma_f32_16x16x16_bf16 v[20:23], v[108:109], v[80:81], v[20:23]
  s_waitcnt lgkmcnt(0)
  v_mfma_f32_16x16x16_bf16 v[24:27], v[112:113], v[80:81], v[24:27]
  s_branch L_donec0
L_slowc0:
  s_mul_i32 s25, s24, 10223616
  s_add_u32 s25, s25, s17
  s_add_u32 s25, s25, 239616
  buffer_load_dwordx3 v[48:50], v59, s[4:7], s25 offen
  s_waitcnt vmcnt(0)
  s_branch L_blkc0
L_morec0:
  s_add_u32 s24, s24, 1
  s_cmp_lg_u32 s24, 1
  s_cbranch_scc1 L_slowc0
  v_mov_b32 v48, v72
  v_mov_b32 v49, v73
  v_mov_b32 v50, v74
  s_branch L_blkc0
L_v4c0:
  v_lshrrev_b32 v121, 16, v48
  v_and_b32 v120, 0xffff, v48
  v_lshlrev_b32 v51, 8, v50
  s_nop 0
  v_add_u32_dpp v76, v120, v55 quad_perm:[0,0,0,0] row_mask:0xf bank_mask:0xf
  v_add_u32_dpp v77, v121, v55 quad_perm:[0,0,0,0] row_mask:0xf bank_mask:0xf
  ds_read_b64_tr_b16 v[84:85], v76 offset:0
  ds_read_b64_tr_b16 v[86:87], v77 offset:0
  ds_read_b64_tr_b16 v[88:89], v76 offset:40960
  ds_read_b64_tr_b16 v[90:91], v77 offset:40960
  v_add_u32_dpp v78, v120, v55 quad_perm:[1,1,1,1] row_mask:0xf bank_mask:0xf
  v_add_u32_dpp v79, v121, v55 quad_perm:[1,1,1,1] row_mask:0xf bank_mask:0xf
  ds_read_b64_tr_b16 v[92:93], v78 offset:0
  ds_read_b64_tr_b16 v[94:95], v79 offset:0
  ds_read_b64_tr_b16 v[96:97], v78 offset:40960
  ds_read_b64_tr_b16 v[98:99], v79 offset:40960
  v_add_u32_dpp v80, v120, v55 quad_perm:[2,2,2,2] row_mask:0xf bank_mask:0xf
  v_add_u32_dpp v81, v121, v55 quad_perm:[2,2,2,2] row_mask:0xf bank_mask:0xf
  ds_read_b64_tr_b16 v[100:101], v80 offset:0
  ds_read_b64_tr_b16 v[102:103], v81 offset:0
  ds_read_b64_tr_b16 v[104:105], v80 offset:40960
  ds_read_b64_tr_b16 v[106:107], v81 offset:40960
  v_add_u32_dpp v82, v120, v55 quad_perm:[3,3,3,3] row_mask:0xf bank_mask:0xf
  v_add_u32_dpp v83, v121, v55 quad_perm:[3,3,3,3] row_mask:0xf bank_mask:0xf
  ds_read_b64_tr_b16 v[108:109], v82 offset:0
  ds_read_b64_tr_b16 v[110:111], v83 offset:0
  ds_read_b64_tr_b16 v[112:113], v82 offset:40960
  ds_read_b64_tr_b16 v[114:115], v83 offset:40960
  v_lshlrev_b64 v[118:119], 1, v[50:51]
  v_pk_ashrrev_i16 v120, 15, v50 op_sel_hi:[0,1]
  v_pk_ashrrev_i16 v121, 15, v51 op_sel_hi:[0,1]
  v_pk_ashrrev_i16 v122, 15, v118 op_sel_hi:[0,1]
  v_pk_ashrrev_i16 v123, 15, v119 op_sel_hi:[0,1]
  v_and_b32_dpp v76, v49, v120 row_newbcast:0 row_mask:0xf bank_mask:0xf
  v_and_b32_dpp v77, v49, v121 row_newbcast:1 row_mask:0xf bank_mask:0xf
  v_and_b32_dpp v78, v49, v122 row_newbcast:2 row_mask:0xf bank_mask:0xf
  v_and_b32_dpp v79, v49, v123 row_newbcast:3 row_mask:0xf bank_mask:0xf
  v_lshlrev_b64 v[116:117], 2, v[50:51]
  v_lshlrev_b64 v[118:119], 3, v[50:51]
  v_pk_ashrrev_i16 v120, 15, v116 op_sel_hi:[0,1]
  v_pk_ashrrev_i16 v121, 15, v117 op_sel_hi:[0,1]
  v_pk_ashrrev_i16 v122, 15, v118 op_sel_hi:[0,1]
  s_waitcnt lgkmcnt(14)
  v_mfma_f32_16x16x32_bf16 v[20:23], v[84:87], v[76:79], v[20:23]
  v_pk_ashrrev_i16 v123, 15, v119 op_sel_hi:[0,1]
  v_and_b32_dpp v80, v49, v120 row_newbcast:4 row_mask:0xf bank_mask:0xf
  v_and_b32_dpp v81, v49, v121 row_newbcast:5 row_mask:0xf bank_mask:0xf
  v_and_b32_dpp v82, v49, v122 row_newbcast:6 row_mask:0xf bank_mask:0xf
  v_and_b32_dpp v83, v49, v123 row_newbcast:7 row_mask:0xf bank_mask:0xf
  s_waitcnt lgkmcnt(12)
  v_mfma_f32_16x16x32_bf16 v[24:27], v[88:91], v[76:79], v[24:27]
  v_lshlrev_b64 v[116:117], 4, v[50:51]
  v_lshlrev_b64 v[118:119], 5, v[50:51]
  v_pk_ashrrev_i16 v120, 15, v116 op_sel_hi:[0,1]
  v_pk_ashrrev_i16 v121, 15, v117 op_sel_hi:[0,1]
  v_pk_ashrrev_i16 v122, 15, v118 op_sel_hi:[0,1]
  s_waitcnt lgkmcnt(10)
  v_mfma_f32_16x16x32_bf16 v[20:23], v[92:95], v[80:83], v[20:23]
  v_pk_ashrrev_i16 v123, 15, v119 op_sel_hi:[0,1]
  v_and_b32_dpp v76, v49, v120 row_newbcast:8 row_mask:0xf bank_mask:0xf
  v_and_b32_dpp v77, v49, v121 row_newbcast:9 row_mask:0xf bank_mask:0xf
  v_and_b32_dpp v78, v49, v122 row_newbcast:10 row_mask:0xf bank_mask:0xf
  v_and_b32_dpp v79, v49, v123 row_newbcast:11 row_mask:0xf bank_mask:0xf
  s_waitcnt lgkmcnt(8)
  v_mfma_f32_16x16x32_bf16 v[24:27], v[96:99], v[80:83], v[24:27]
  v_lshlrev_b64 v[116:117], 6, v[50:51]
  v_lshlrev_b64 v[118:119], 7, v[50:51]
  v_pk_ashrrev_i16 v120, 15, v116 op_sel_hi:[0,1]
  v_pk_ashrrev_i16 v121, 15, v117 op_sel_hi:[0,1]
  v_pk_ashrrev_i16 v122, 15, v118 op_sel_hi:[0,1]
  s_waitcnt lgkmcnt(6)
  v_mfma_f32_16x16x32_bf16 v[20:23], v[100:103], v[76:79], v[20:23]
  v_pk_ashrrev_i16 v123, 15, v119 op_sel_hi:[0,1]
  v_and_b32_dpp v80, v49, v120 row_newbcast:12 row_mask:0xf bank_mask:0xf
  v_and_b32_dpp v81, v49, v121 row_newbcast:13 row_mask:0xf bank_mask:0xf
  v_and_b32_dpp v82, v49, v122 row_newbcast:14 row_mask:0xf bank_mask:0xf
  v_and_b32_dpp v83, v49, v123 row_newbcast:15 row_mask:0xf bank_mask:0xf
  s_waitcnt lgkmcnt(4)
  v_mfma_f32_16x16x32_bf16 v[24:27], v[104:107], v[76:79], v[24:27]
  s_waitcnt lgkmcnt(2)
  s_nop 0
  v_mfma_f32_16x16x32_bf16 v[20:23], v[108:111], v[80:83], v[20:23]
  s_waitcnt lgkmcnt(0)
  v_mfma_f32_16x16x32_bf16 v[24:27], v[112:115], v[80:83], v[24:27]
  s_sub_u32 s46, s46, 8
  s_cmp_lg_u32 s46, 0
  s_cbranch_scc1 L_morec0
L_donec0:
  s_cmp_ge_u32 s29, 8
  s_cbranch_scc1 L_nfc0
  s_add_u32 s26, s16, 34
  s_add_u32 s25, s17, 241152
  v_readlane_b32 s46, v63, s26
  buffer_load_dwordx3 v[48:50], v59, s[4:7], s25 offen
  s_cmp_le_u32 s46, 8
  s_cbranch_scc1 L_nfc0
  s_add_u32 s25, s25, 10223616
  buffer_load_dwordx3 v[72:74], v59, s[4:7], s25 offen
L_nfc0:
  s_setprio 2
  s_mov_b32 s24, 0
L_blka0:
  s_cmp_ge_u32 s44, 8
  s_cbranch_scc1 L_v4a0
  s_cmp_eq_u32 s44, 7
  s_cbranch_scc1 L_w7a0
  s_cmp_eq_u32 s44, 6
  s_cbranch_scc1 L_w6a0
  s_cmp_eq_u32 s44, 5
  s_cbranch_scc1 L_w5a0
  s_cmp_eq_u32 s44, 4
  s_cbranch_scc1 L_w4a0
  s_cmp_eq_u32 s44, 3
  s_cbranch_scc1 L_w3a0
  s_cmp_eq_u32 s44, 2
  s_cbranch_scc1 L_w2a0
  s_cmp_eq_u32 s44, 0
  s_cbranch_scc1 L_donea0
L_w1a0:
  v_and_b32 v120, 0xffff, v40
  v_lshlrev_b32 v43, 8, v42
  s_nop 0
  v_add_u32_dpp v76, v120, v55 quad_perm:[0,0,0,0] row_mask:0xf bank_mask:0xf
  ds_read_b64_tr_b16 v[84:85], v76 offset:0
  ds_read_b64_tr_b16 v[88:89], v76 offset:40960
  v_pk_ashrrev_i16 v120, 15, v42 op_sel_hi:[0,1]
  v_pk_ashrrev_i16 v121, 15, v43 op_sel_hi:[0,1]
  v_and_b32_dpp v76, v41, v120 row_newbcast:0 row_mask:0xf bank_mask:0xf
  v_and_b32_dpp v77, v41, v121 row_newbcast:1 row_mask:0xf bank_mask:0xf
  s_waitcnt lgkmcnt(1)
  s_nop 0
  v_mfma_f32_16x16x16_bf16 v[4:7], v[84:85], v[76:77], v[4:7]
  s_waitcnt lgkmcnt(0)
  v_mfma_f32_16x16x16_bf16 v[8:11], v[88:89], v[76:77], v[8:11]
  s_branch L_donea0
L_w2a0:
  v_lshrrev_b32 v121, 16, v40
  v_and_b32 v120, 0xffff, v40
  v_lshlrev_b32 v43, 8, v42
  s_nop 0
  v_add_u32_dpp v76, v120, v55 quad_perm:[0,0,0,0] row_mask:0xf bank_mask:0xf
  v_add_u32_dpp v77, v121, v55 quad_perm:[0,0,0,0] row_mask:0xf bank_mask:0xf
  ds_read_b64_tr_b16 v[84:85], v76 offset:0
  ds_read_b64_tr_b16 v[86:87], v77 offset:0
  ds_read_b64_tr_b16 v[88:89], v76 offset:40960
  ds_read_b64_tr_b16 v[90:91], v77 offset:40960
  v_lshlrev_b64 v[118:119], 1, v[42:43]
  v_pk_ashrrev_i16 v120, 15, v42 op_sel_hi:[0,1]
  v_pk_ashrrev_i16 v121, 15, v43 op_sel_hi:[0,1]
  v_pk_ashrrev_i16 v122, 15, v118 op_sel_hi:[0,1]
  v_pk_ashrrev_i16 v123, 15, v119 op_sel_hi:[0,1]
  v_and_b32_dpp v76, v41, v120 row_newbcast:0 row_mask:0xf bank_mask:0xf
  v_and_b32_dpp v77, v41, v121 row_newbcast:1 row_mask:0xf bank_mask:0xf
  v_and_b32_dpp v78, v41, v122 row_newbcast:2 row_mask:0xf bank_mask:0xf
  v_and_b32_dpp v79, v41, v123 row_newbcast:3 row_mask:0xf bank_mask:0xf
  s_waitcnt lgkmcnt(2)
  s_nop 0
  v_mfma_f32_16x16x32_bf16 v[4:7], v[84:87], v[76:79], v[4:7]
  s_waitcnt lgkmcnt(0)
  v_mfma_f32_16x16x32_bf16 v[8:11], v[88:91], v[76:79], v[8:11]
  s_branch L_donea0
L_w3a0:
  v_lshrrev_b32 v121, 16, v40
  v_and_b32 v120, 0xffff, v40
  v_lshlrev_b32 v43, 8, v42
  s_nop 0
  v_add_u32_dpp v76, v120, v55 quad_perm:[0,0,0,0] row_mask:0xf bank_mask:0xf
  v_add_u32_dpp v77, v121, v55 quad_perm:[0,0,0,0] row_mask:0xf bank_mask:0xf
  ds_read_b64_tr_b16 v[84:85], v76 offset:0
  ds_read_b64_tr_b16 v[86:87], v77 offset:0
  ds_read_b64_tr_b16 v[88:89], v76 offset:40960
  ds_read_b64_tr_b16 v[90:91], v77 offset:40960
  v_add_u32_dpp v78, v120, v55 quad_perm:[1,1,1,1] row_mask:0xf bank_mask:0xf
  ds_read_b64_tr_b16 v[92:93], v78 offset:0
  ds_read_b64_tr_b16 v[96:97], v78 offset:40960
  v_lshlrev_b64 v[118:119], 1, v[42:43]
  v_pk_ashrrev_i16 v120, 15, v42 op_sel_hi:[0,1]
  v_pk_ashrrev_i16 v121, 15, v43 op_sel_hi:[0,1]
  v_pk_ashrrev_i16 v122, 15, v118 op_sel_hi:[0,1]
  v_pk_ashrrev_i16 v123, 15, v119 op_sel_hi:[0,1]
  v_and_b32_dpp v76, v41, v120 row_newbcast:0 row_mask:0xf bank_mask:0xf
  v_and_b32_dpp v77, v41, v121 row_newbcast:1 row_mask:0xf bank_mask:0xf
  v_and_b32_dpp v78, v41, v122 row_newbcast:2 row_mask:0xf bank_mask:0xf
  v_and_b32_dpp v79, v41, v123 row_newbcast:3 row_mask:0xf bank_mask:0xf
  v_lshlrev_b64 v[116:117], 2, v[42:43]
  v_pk_ashrrev_i16 v120, 15, v116 op_sel_hi:[0,1]
  v_pk_ashrrev_i16 v121, 15, v117 op_sel_hi:[0,1]
  s_waitcnt lgkmcnt(4)
  v_mfma_f32_16x16x32_bf16 v[4:7], v[84:87], v[76:79], v[4:7]
  v_and_b32_dpp v80, v41, v120 row_newbcast:4 row_mask:0xf bank_mask:0xf
  v_and_b32_dpp v81, v41, v121 row_newbcast:5 row_mask:0xf bank_mask:0xf
  s_waitcnt lgkmcnt(2)
  v_mfma_f32_16x16x32_bf16 v[8:11], v[88:91], v[76:79], v[8:11]
  s_waitcnt lgkmcnt(1)
  s_nop 0
  v_mfma_f32_16x16x16_bf16 v[4:7], v[92:93], v[80:81], v[4:7]
  s_waitcnt lgkmcnt(0)
  v_mfma_f32_16x16x16_bf16 v[8:11], v[96:97], v[80:81], v[8:11]
  s_branch L_donea0
L_w4a0:
  v_lshrrev_b32 v121, 16, v40
  v_and_b32 v120, 0xffff, v40
  v_lshlrev_b32 v43, 8, v42
  s_nop 0
  v_add_u32_dpp v76, v120, v55 quad_perm:[0,0,0,0] row_mask:0xf bank_mask:0xf
  v_add_u32_dpp v77, v121, v55 quad_perm:[0,0,0,0] row_mask:0xf bank_mask:0xf
  ds_read_b64_tr_b16 v[84:85], v76 offset:0
  ds_read_b64_tr_b16 v[86:87], v77 offset:0
  ds_read_b64_tr_b16 v[88:89], v76 offset:40960
  ds_read_b64_tr_b16 v[90:91], v77 offset:40960
  v_add_u32_dpp v78, v120, v55 quad_perm:[1,1,1,1] row_mask:0xf bank_mask:0xf
  v_add_u32_dpp v79, v121, v55 quad_perm:[1,1,1,1] row_mask:0xf bank_mask:0xf
  ds_read_b64_tr_b16 v[92:93], v78 offset:0
  ds_read_b64_tr_b16 v[94:95], v79 offset:0
  ds_read_b64_tr_b16 v[96:97], v78 offset:40960
  ds_read_b64_tr_b16 v[98:99], v79 offset:40960
  v_lshlrev_b64 v[118:119], 1, v[42:43]
  v_pk_ashrrev_i16 v120, 15, v42 op_sel_hi:[0,1]
  v_pk_ashrrev_i16 v121, 15, v43 op_sel_hi:[0,1]
  v_pk_ashrrev_i16 v122, 15, v118 op_sel_hi:[0,1]
  v_pk_ashrrev_i16 v123, 15, v119 op_sel_hi:[0,1]
  v_and_b32_dpp v76, v41, v120 row_newbcast:0 row_mask:0xf bank_mask:0xf
  v_and_b32_dpp v77, v41, v121 row_newbcast:1 row_mask:0xf bank_mask:0xf
  v_and_b32_dpp v78, v41, v122 row_newbcast:2 row_mask:0xf bank_mask:0xf
  v_and_b32_dpp v79, v41, v123 row_newbcast:3 row_mask:0xf bank_mask:0xf
  v_lshlrev_b64 v[116:117], 2, v[42:43]
  v_lshlrev_b64 v[118:119], 3, v[42:43]
  v_pk_ashrrev_i16 v120, 15, v116 op_sel_hi:[0,1]
  v_pk_ashrrev_i16 v121, 15, v117 op_sel_hi:[0,1]
  v_pk_ashrrev_i16 v122, 15, v118 op_sel_hi:[0,1]
  s_waitcnt lgkmcnt(6)
  v_mfma_f32_16x16x32_bf16 v[4:7], v[84:87], v[76:79], v[4:7]
  v_pk_ashrrev_i16 v123, 15, v119 op_sel_hi:[0,1]
  v_and_b32_dpp v80, v41, v120 row_newbcast:4 row_mask:0xf bank_mask:0xf
  v_and_b32_dpp v81, v41, v121 row_newbcast:5 row_mask:0xf bank_mask:0xf
  v_and_b32_dpp v82, v41, v122 row_newbcast:6 row_mask:0xf bank_mask:0xf
  v_and_b32_dpp v83, v41, v123 row_newbcast:7 row_mask:0xf bank_mask:0xf
  s_waitcnt lgkmcnt(4)
  v_mfma_f32_16x16x32_bf16 v[8:11], v[88:91], v[76:79], v[8:11]
  s_waitcnt lgkmcnt(2)
  s_nop 0
  v_mfma_f32_16x16x32_bf16 v[4:7], v[92:95], v[80:83], v[4:7]
  s_waitcnt lgkmcnt(0)
  v_mfma_f32_16x16x32_bf16 v[8:11], v[96:99], v[80:83], v[8:11]
  s_branch L_donea0
L_w5a0:
  v_lshrrev_b32 v121, 16, v40
  v_and_b32 v120, 0xffff, v40
  v_lshlrev_b32 v43, 8, v42
  s_nop 0
  v_add_u32_dpp v76, v120, v55 quad_perm:[0,0,0,0] row_mask:0xf bank_mask:0xf
  v_add_u32_dpp v77, v121, v55 quad_perm:[0,0,0,0] row_mask:0xf bank_mask:0xf
  ds_read_b64_tr_b16 v[84:85], v76 offset:0
  ds_read_b64_tr_b16 v[86:87], v77 offset:0
  ds_read_b64_tr_b16 v[88:89], v76 offset:40960
  ds_read_b64_tr_b16 v[90:91], v77 offset:40960
  v_add_u32_dpp v78, v120, v55 quad_perm:[1,1,1,1] row_mask:0xf bank_mask:0xf
  v_add_u32_dpp v79, v121, v55 quad_perm:[1,1,1,1] row_mask:0xf bank_mask:0xf
  ds_read_b64_tr_b16 v[92:93], v78 offset:0
  ds_read_b64_tr_b16 v[94:95], v79 offset:0
  ds_read_b64_tr_b16 v[96:97], v78 offset:40960
  ds_read_b64_tr_b16 v[98:99], v79 offset:40960
  v_add_u32_dpp v80, v120, v55 quad_perm:[2,2,2,2] row_mask:0xf bank_mask:0xf
  ds_read_b64_tr_b16 v[100:101], v80 offset:0
  ds_read_b64_tr_b16 v[104:105], v80 offset:40960
  v_lshlrev_b64 v[118:119], 1, v[42:43]
  v_pk_ashrrev_i16 v120, 15, v42 op_sel_hi:[0,1]
  v_pk_ashrrev_i16 v121, 15, v43 op_sel_hi:[0,1]
  v_pk_ashrrev_i16 v122, 15, v118 op_sel_hi:[0,1]
  v_pk_ashrrev_i16 v123, 15, v119 op_sel_hi:[0,1]
  v_and_b32_dpp v76, v41, v120 row_newbcast:0 row_mask:0xf bank_mask:0xf
  v_and_b32_dpp v77, v41, v121 row_newbcast:1 row_mask:0xf bank_mask:0xf
  v_and_b32_dpp v78, v41, v122 row_newbcast:2 row_mask:0xf bank_mask:0xf
  v_and_b32_dpp v79, v41, v123 row_newbcast:3 row_mask:0xf bank_mask:0xf
  v_lshlrev_b64 v[116:117], 2, v[42:43]
  v_lshlrev_b64 v[118:119], 3, v[42:43]
  v_pk_ashrrev_i16 v120, 15, v116 op_sel_hi:[0,1]
  v_pk_ashrrev_i16 v121, 15, v117 op_sel_hi:[0,1]
  v_pk_ashrrev_i16 v122, 15, v118 op_sel_hi:[0,1]
  s_waitcnt lgkmcnt(8)
  v_mfma_f32_16x16x32_bf16 v[4:7], v[84:87], v[76:79], v[4:7]
  v_pk_ashrrev_i16 v123, 15, v119 op_sel_hi:[0,1]
  v_and_b32_dpp v80, v41, v120 row_newbcast:4 row_mask:0xf bank_mask:0xf
  v_and_b32_dpp v81, v41, v121 row_newbcast:5 row_mask:0xf bank_mask:0xf
  v_and_b32_dpp v82, v41, v122 row_newbcast:6 row_mask:0xf bank_mask:0xf
  v_and_b32_dpp v83, v41, v123 row_newbcast:7 row_mask:0xf bank_mask:0xf
  s_waitcnt lgkmcnt(6)
  v_mfma_f32_16x16x32_bf16 v[8:11], v[88:91], v[76:79], v[8:11]
  v_lshlrev_b64 v[116:117], 4, v[42:43]
  v_pk_ashrrev_i16 v120, 15, v116 op_sel_hi:[0,1]
  v_pk_ashrrev_i16 v121, 15, v117 op_sel_hi:[0,1]
  s_waitcnt lgkmcnt(4)
  v_mfma_f32_16x16x32_bf16 v[4:7], v[92:95], v[80:83], v[4:7]
  v_and_b32_dpp v76, v41, v120 row_newbcast:8 row_mask:0xf bank_mask:0xf
  v_and_b32_dpp v77, v41, v121 row_newbcast:9 row_mask:0xf bank_mask:0xf
  s_waitcnt lgkmcnt(2)
  v_mfma_f32_16x16x32_bf16 v[8:11], v[96:99], v[80:83], v[8:11]
  s_waitcnt lgkmcnt(1)
  s_nop 0
  v_mfma_f32_16x16x16_bf16 v[4:7], v[100:101], v[76:77], v[4:7]
  s_waitcnt lgkmcnt(0)
  v_mfma_f32_16x16x16_bf16 v[8:11], v[104:105], v[76:77], v[8:11]
  s_branch L_donea0
L_w6a0:
  v_lshrrev_b32 v121, 16, v40
  v_and_b32 v120, 0xffff, v40
  v_lshlrev_b32 v43, 8, v42
  s_nop 0
  v_add_u32_dpp v76, v120, v55 quad_perm:[0,0,0,0] row_mask:0xf bank_mask:0xf
  v_add_u32_dpp v77, v121, v55 quad_perm:[0,0,0,0] row_mask:0xf bank_mask:0xf
  ds_read_b64_tr_b16 v[84:85], v76 offset:0
  ds_read_b64_tr_b16 v[86:87], v77 offset:0
  ds_read_b64_tr_b16 v[88:89], v76 offset:40960
  ds_read_b64_tr_b16 v[90:91], v77 offset:40960
  v_add_u32_dpp v78, v120, v55 quad_perm:[1,1,1,1] row_mask:0xf bank_mask:0xf
  v_add_u32_dpp v79, v121, v55 quad_perm:[1,1,1,1] row_mask:0xf bank_mask:0xf
  ds_read_b64_tr_b16 v[92:93], v78 offset:0
  ds_read_b64_tr_b16 v[94:95], v79 offset:0
  ds_read_b64_tr_b16 v[96:97], v78 offset:40960
  ds_read_b64_tr_b16 v[98:99], v79 offset:40960
  v_add_u32_dpp v80, v120, v55 quad_perm:[2,2,2,2] row_mask:0xf bank_mask:0xf
  v_add_u32_dpp v81, v121, v55 quad_perm:[2,2,2,2] row_mask:0xf bank_mask:0xf
  ds_read_b64_tr_b16 v[100:101], v80 offset:0
  ds_read_b64_tr_b16 v[102:103], v81 offset:0
  ds_read_b64_tr_b16 v[104:105], v80 offset:40960
  ds_read_b64_tr_b16 v[106:107], v81 offset:40960
  v_lshlrev_b64 v[118:119], 1, v[42:43]
  v_pk_ashrrev_i16 v120, 15, v42 op_sel_hi:[0,1]
  v_pk_ashrrev_i16 v121, 15, v43 op_sel_hi:[0,1]
  v_pk_ashrrev_i16 v122, 15, v118 op_sel_hi:[0,1]
  v_pk_ashrrev_i16 v123, 15, v119 op_sel_hi:[0,1]
  v_and_b32_dpp v76, v41, v120 row_newbcast:0 row_mask:0xf bank_mask:0xf
  v_and_b32_dpp v77, v41, v121 row_newbcast:1 row_mask:0xf bank_mask:0xf
  v_and_b32_dpp v78, v41, v122 row_newbcast:2 row_mask:0xf bank_mask:0xf
  v_and_b32_dpp v79, v41, v123 row_newbcast:3 row_mask:0xf bank_mask:0xf
  v_lshlrev_b64 v[116:117], 2, v[42:43]
  v_lshlrev_b64 v[118:119], 3, v[42:43]
  v_pk_ashrrev_i16 v120, 15, v116 op_sel_hi:[0,1]
  v_pk_ashrrev_i16 v121, 15, v117 op_sel_hi:[0,1]
  v_pk_ashrrev_i16 v122, 15, v118 op_sel_hi:[0,1]
  s_waitcnt lgkmcnt(10)
  v_mfma_f32_16x16x32_bf16 v[4:7], v[84:87], v[76:79], v[4:7]
  v_pk_ashrrev_i16 v123, 15, v119 op_sel_hi:[0,1]
  v_and_b32_dpp v80, v41, v120 row_newbcast:4 row_mask:0xf bank_mask:0xf
  v_and_b32_dpp v81, v41, v121 row_newbcast:5 row_mask:0xf bank_mask:0xf
  v_and_b32_dpp v82, v41, v122 row_newbcast:6 row_mask:0xf bank_mask:0xf
  v_and_b32_dpp v83, v41, v123 row_newbcast:7 row_mask:0xf bank_mask:0xf
  s_waitcnt lgkmcnt(8)
  v_mfma_f32_16x16x32_bf16 v[8:11], v[88:91], v[76:79], v[8:11]
  v_lshlrev_b64 v[116:117], 4, v[42:43]
  v_lshlrev_b64 v[118:119], 5, v[42:43]
  v_pk_ashrrev_i16 v120, 15, v116 op_sel_hi:[0,1]
  v_pk_ashrrev_i16 v121, 15, v117 op_sel_hi:[0,1]
  v_pk_ashrrev_i16 v122, 15, v118 op_sel_hi:[0,1]
  s_waitcnt lgkmcnt(6)
  v_mfma_f32_16x16x32_bf16 v[4:7], v[92:95], v[80:83], v[4:7]
  v_pk_ashrrev_i16 v123, 15, v119 op_sel_hi:[0,1]
  v_and_b32_dpp v76, v41, v120 row_newbcast:8 row_mask:0xf bank_mask:0xf
  v_and_b32_dpp v77, v41, v121 row_newbcast:9 row_mask:0xf bank_mask:0xf
  v_and_b32_dpp v78, v41, v122 row_newbcast:10 row_mask:0xf bank_mask:0xf
  v_and_b32_dpp v79, v41, v123 row_newbcast:11 row_mask:0xf bank_mask:0xf
  s_waitcnt lgkmcnt(4)
  v_mfma_f32_16x16x32_bf16 v[8:11], v[96:99], v[80:83], v[8:11]
  s_waitcnt lgkmcnt(2)
  s_nop 0
  v_mfma_f32_16x16x32_bf16 v[4:7], v[100:103], v[76:79], v[4:7]
  s_waitcnt lgkmcnt(0)
  v_mfma_f32_16x16x32_bf16 v[8:11], v[104:107], v[76:79], v[8:11]
  s_branch L_donea0
L_w7a0:
  v_lshrrev_b32 v121, 16, v40
  v_and_b32 v120, 0xffff, v40
  v_lshlrev_b32 v43, 8, v42
  s_nop 0
  v_add_u32_dpp v76, v120, v55 quad_perm:[0,0,0,0] row_mask:0xf bank_mask:0xf
  v_add_u32_dpp v77, v121, v55 quad_perm:[0,0,0,0] row_mask:0xf bank_mask:0xf
  ds_read_b64_tr_b16 v[84:85], v76 offset:0
  ds_read_b64_tr_b16 v[86:87], v77 offset:0
  ds_read_b64_tr_b16 v[88:89], v76 offset:40960
  ds_read_b64_tr_b16 v[90:91], v77 offset:40960
  v_add_u32_dpp v78, v120, v55 quad_perm:[1,1,1,1] row_mask:0xf bank_mask:0xf
  v_add_u32_dpp v79, v121, v55 quad_perm:[1,1,1,1] row_mask:0xf bank_mask:0xf
  ds_read_b64_tr_b16 v[92:93], v78 offset:0
  ds_read_b64_tr_b16 v[94:95], v79 offset:0
  ds_read_b64_tr_b16 v[96:97], v78 offset:40960
  ds_read_b64_tr_b16 v[98:99], v79 offset:40960
  v_add_u32_dpp v80, v120, v55 quad_perm:[2,2,2,2] row_mask:0xf bank_mask:0xf
  v_add_u32_dpp v81, v121, v55 quad_perm:[2,2,2,2] row_mask:0xf bank_mask:0xf
  ds_read_b64_tr_b16 v[100:101], v80 offset:0
  ds_read_b64_tr_b16 v[102:103], v81 offset:0
  ds_read_b64_tr_b16 v[104:105], v80 offset:40960
  ds_read_b64_tr_b16 v[106:107], v81 offset:40960
  v_add_u32_dpp v82, v120, v55 quad_perm:[3,3,3,3] row_mask:0xf bank_mask:0xf
  ds_read_b64_tr_b16 v[108:109], v82 offset:0
  ds_read_b64_tr_b16 v[112:113], v82 offset:40960
  v_lshlrev_b64 v[118:119], 1, v[42:43]
  v_pk_ashrrev_i16 v120, 15, v42 op_sel_hi:[0,1]
  v_pk_ashrrev_i16 v121, 15, v43 op_sel_hi:[0,1]
  v_pk_ashrrev_i16 v122, 15, v118 op_sel_hi:[0,1]
  v_pk_ashrrev_i16 v123, 15, v119 op_sel_hi:[0,1]
  v_and_b32_dpp v76, v41, v120 row_newbcast:0 row_mask:0xf bank_mask:0xf
  v_and_b32_dpp v77, v41, v121 row_newbcast:1 row_mask:0xf bank_mask:0xf
  v_and_b32_dpp v78, v41, v122 row_newbcast:2 row_mask:0xf bank_mask:0xf
  v_and_b32_dpp v79, v41, v123 row_newbcast:3 row_mask:0xf bank_mask:0xf
  v_lshlrev_b64 v[116:117], 2, v[42:43]
  v_lshlrev_b64 v[118:119], 3, v[42:43]
  v_pk_ashrrev_i16 v120, 15, v116 op_sel_hi:[0,1]
  v_pk_ashrrev_i16 v121, 15, v117 op_sel_hi:[0,1]
  v_pk_ashrrev_i16 v122, 15, v118 op_sel_hi:[0,1]
  s_waitcnt lgkmcnt(12)
  v_mfma_f32_16x16x32_bf16 v[4:7], v[84:87], v[76:79], v[4:7]
  v_pk_ashrrev_i16 v123, 15, v119 op_sel_hi:[0,1]
  v_and_b32_dpp v80, v41, v120 row_newbcast:4 row_mask:0xf bank_mask:0xf
  v_and_b32_dpp v81, v41, v121 row_newbcast:5 row_mask:0xf bank_mask:0xf
  v_and_b32_dpp v82, v41, v122 row_newbcast:6 row_mask:0xf bank_mask:0xf
  v_and_b32_dpp v83, v41, v123 row_newbcast:7 row_mask:0xf bank_mask:0xf
  s_waitcnt lgkmcnt(10)
  v_mfma_f32_16x16x32_bf16 v[8:11], v[88:91], v[76:79], v[8:11]
  v_lshlrev_b64 v[116:117], 4, v[42:43]
  v_lshlrev_b64 v[118:119], 5, v[42:43]
  v_pk_ashrrev_i16 v120, 15, v116 op_sel_hi:[0,1]
  v_pk_ashrrev_i16 v121, 15, v117 op_sel_hi:[0,1]
  v_pk_ashrrev_i16 v122, 15, v118 op_sel_hi:[0,1]
  s_waitcnt lgkmcnt(8)
  v_mfma_f32_16x16x32_bf16 v[4:7], v[92:95], v[80:83], v[4:7]
  v_pk_ashrrev_i16 v123, 15, v119 op_sel_hi:[0,1]
  v_and_b32_dpp v76, v41, v120 row_newbcast:8 row_mask:0xf bank_mask:0xf
  v_and_b32_dpp v77, v41, v121 row_newbcast:9 row_mask:0xf bank_mask:0xf
  v_and_b32_dpp v78, v41, v122 row_newbcast:10 row_mask:0xf bank_mask:0xf
  v_and_b32_dpp v79, v41, v123 row_newbcast:11 row_mask:0xf bank_mask:0xf
  s_waitcnt lgkmcnt(6)
  v_mfma_f32_16x16x32_bf16 v[8:11], v[96:99], v[80:83], v[8:11]
  v_lshlrev_b64 v[116:117], 6, v[42:43]
  v_pk_ashrrev_i16 v120, 15, v116 op_sel_hi:[0,1]
  v_pk_ashrrev_i16 v121, 15, v117 op_sel_hi:[0,1]
  s_waitcnt lgkmcnt(4)
  v_mfma_f32_16x16x32_bf16 v[4:7], v[100:103], v[76:79], v[4:7]
  v_and_b32_dpp v80, v41, v120 row_newbcast:12 row_mask:0xf bank_mask:0xf
  v_and_b32_dpp v81, v41, v121 row_newbcast:13 row_mask:0xf bank_mask:0xf
  s_waitcnt lgkmcnt(2)
  v_mfma_f32_16x16x32_bf16 v[8:11], v[104:107], v[76:79], v[8:11]
  s_waitcnt lgkmcnt(1)
  s_nop 0
  v_mfma_f32_16x16x16_bf16 v[4:7], v[108:109], v[80:81], v[4:7]
  s_waitcnt lgkmcnt(0)
  v_mfma_f32_16x16x16_bf16 v[8:11], v[112:113], v[80:81], v[8:11]
  s_branch L_donea0
L_slowa0:
  s_mul_i32 s25, s24, 10223616
  s_add_u32 s25, s25, s17
  s_add_u32 s25, s25, 0
  buffer_load_dwordx3 v[40:42], v59, s[4:7], s25 offen
  s_waitcnt vmcnt(0)
  s_branch L_blka0
L_morea0:
  s_add_u32 s24, s24, 1
  s_cmp_lg_u32 s24, 1
  s_cbranch_scc1 L_slowa0
  v_mov_b32 v40, v64
  v_mov_b32 v41, v65
  v_mov_b32 v42, v66
  s_branch L_blka0
L_v4a0:
  v_lshrrev_b32 v121, 16, v40
  v_and_b32 v120, 0xffff, v40
  v_lshlrev_b32 v43, 8, v42
  s_nop 0
  v_add_u32_dpp v76, v120, v55 quad_perm:[0,0,0,0] row_mask:0xf bank_mask:0xf
  v_add_u32_dpp v77, v121, v55 quad_perm:[0,0,0,0] row_mask:0xf bank_mask:0xf
  ds_read_b64_tr_b16 v[84:85], v76 offset:0
  ds_read_b64_tr_b16 v[86:87], v77 offset:0
  ds_read_b64_tr_b16 v[88:89], v76 offset:40960
  ds_read_b64_tr_b16 v[90:91], v77 offset:40960
  v_add_u32_dpp v78, v120, v55 quad_perm:[1,1,1,1] row_mask:0xf bank_mask:0xf
  v_add_u32_dpp v79, v121, v55 quad_perm:[1,1,1,1] row_mask:0xf bank_mask:0xf
  ds_read_b64_tr_b16 v[92:93], v78 offset:0
  ds_read_b64_tr_b16 v[94:95], v79 offset:0
  ds_read_b64_tr_b16 v[96:97], v78 offset:40960
  ds_read_b64_tr_b16 v[98:99], v79 offset:40960
  v_add_u32_dpp v80, v120, v55 quad_perm:[2,2,2,2] row_mask:0xf bank_mask:0xf
  v_add_u32_dpp v81, v121, v55 quad_perm:[2,2,2,2] row_mask:0xf bank_mask:0xf
  ds_read_b64_tr_b16 v[100:101], v80 offset:0
  ds_read_b64_tr_b16 v[102:103], v81 offset:0
  ds_read_b64_tr_b16 v[104:105], v80 offset:40960
  ds_read_b64_tr_b16 v[106:107], v81 offset:40960
  v_add_u32_dpp v82, v120, v55 quad_perm:[3,3,3,3] row_mask:0xf bank_mask:0xf
  v_add_u32_dpp v83, v121, v55 quad_perm:[3,3,3,3] row_mask:0xf bank_mask:0xf
  ds_read_b64_tr_b16 v[108:109], v82 offset:0
  ds_read_b64_tr_b16 v[110:111], v83 offset:0
  ds_read_b64_tr_b16 v[112:113], v82 offset:40960
  ds_read_b64_tr_b16 v[114:115], v83 offset:40960
  v_lshlrev_b64 v[118:119], 1, v[42:43]
  v_pk_ashrrev_i16 v120, 15, v42 op_sel_hi:[0,1]
  v_pk_ashrrev_i16 v121, 15, v43 op_sel_hi:[0,1]
  v_pk_ashrrev_i16 v122, 15, v118 op_sel_hi:[0,1]
  v_pk_ashrrev_i16 v123, 15, v119 op_sel_hi:[0,1]
  v_and_b32_dpp v76, v41, v120 row_newbcast:0 row_mask:0xf bank_mask:0xf
  v_and_b32_dpp v77, v41, v121 row_newbcast:1 row_mask:0xf bank_mask:0xf
  v_and_b32_dpp v78, v41, v122 row_newbcast:2 row_mask:0xf bank_mask:0xf
  v_and_b32_dpp v79, v41, v123 row_newbcast:3 row_mask:0xf bank_mask:0xf
  v_lshlrev_b64 v[116:117], 2, v[42:43]
  v_lshlrev_b64 v[118:119], 3, v[42:43]
  v_pk_ashrrev_i16 v120, 15, v116 op_sel_hi:[0,1]
  v_pk_ashrrev_i16 v121, 15, v117 op_sel_hi:[0,1]
  v_pk_ashrrev_i16 v122, 15, v118 op_sel_hi:[0,1]
  s_waitcnt lgkmcnt(14)
  v_mfma_f32_16x16x32_bf16 v[4:7], v[84:87], v[76:79], v[4:7]
  v_pk_ashrrev_i16 v123, 15, v119 op_sel_hi:[0,1]
  v_and_b32_dpp v80, v41, v120 row_newbcast:4 row_mask:0xf bank_mask:0xf
  v_and_b32_dpp v81, v41, v121 row_newbcast:5 row_mask:0xf bank_mask:0xf
  v_and_b32_dpp v82, v41, v122 row_newbcast:6 row_mask:0xf bank_mask:0xf
  v_and_b32_dpp v83, v41, v123 row_newbcast:7 row_mask:0xf bank_mask:0xf
  s_waitcnt lgkmcnt(12)
  v_mfma_f32_16x16x32_bf16 v[8:11], v[88:91], v[76:79], v[8:11]
  v_lshlrev_b64 v[116:117], 4, v[42:43]
  v_lshlrev_b64 v[118:119], 5, v[42:43]
  v_pk_ashrrev_i16 v120, 15, v116 op_sel_hi:[0,1]
  v_pk_ashrrev_i16 v121, 15, v117 op_sel_hi:[0,1]
  v_pk_ashrrev_i16 v122, 15, v118 op_sel_hi:[0,1]
  s_waitcnt lgkmcnt(10)
  v_mfma_f32_16x16x32_bf16 v[4:7], v[92:95], v[80:83], v[4:7]
  v_pk_ashrrev_i16 v123, 15, v119 op_sel_hi:[0,1]
  v_and_b32_dpp v76, v41, v120 row_newbcast:8 row_mask:0xf bank_mask:0xf
  v_and_b32_dpp v77, v41, v121 row_newbcast:9 row_mask:0xf bank_mask:0xf
  v_and_b32_dpp v78, v41, v122 row_newbcast:10 row_mask:0xf bank_mask:0xf
  v_and_b32_dpp v79, v41, v123 row_newbcast:11 row_mask:0xf bank_mask:0xf
  s_waitcnt lgkmcnt(8)
  v_mfma_f32_16x16x32_bf16 v[8:11], v[96:99], v[80:83], v[8:11]
  v_lshlrev_b64 v[116:117], 6, v[42:43]
  v_lshlrev_b64 v[118:119], 7, v[42:43]
  v_pk_ashrrev_i16 v120, 15, v116 op_sel_hi:[0,1]
  v_pk_ashrrev_i16 v121, 15, v117 op_sel_hi:[0,1]
  v_pk_ashrrev_i16 v122, 15, v118 op_sel_hi:[0,1]
  s_waitcnt lgkmcnt(6)
  v_mfma_f32_16x16x32_bf16 v[4:7], v[100:103], v[76:79], v[4:7]
  v_pk_ashrrev_i16 v123, 15, v119 op_sel_hi:[0,1]
  v_and_b32_dpp v80, v41, v120 row_newbcast:12 row_mask:0xf bank_mask:0xf
  v_and_b32_dpp v81, v41, v121 row_newbcast:13 row_mask:0xf bank_mask:0xf
  v_and_b32_dpp v82, v41, v122 row_newbcast:14 row_mask:0xf bank_mask:0xf
  v_and_b32_dpp v83, v41, v123 row_newbcast:15 row_mask:0xf bank_mask:0xf
  s_waitcnt lgkmcnt(4)
  v_mfma_f32_16x16x32_bf16 v[8:11], v[104:107], v[76:79], v[8:11]
  s_waitcnt lgkmcnt(2)
  s_nop 0
  v_mfma_f32_16x16x32_bf16 v[4:7], v[108:111], v[80:83], v[4:7]
  s_waitcnt lgkmcnt(0)
  v_mfma_f32_16x16x32_bf16 v[8:11], v[112:115], v[80:83], v[8:11]
  s_sub_u32 s44, s44, 8
  s_cmp_lg_u32 s44, 0
  s_cbranch_scc1 L_morea0
L_donea0:
  s_add_u32 s26, s16, 2
  s_add_u32 s25, s17, 1536
  v_readlane_b32 s44, v63, s26
  buffer_load_dwordx3 v[40:42], v59, s[4:7], s25 offen
  s_cmp_le_u32 s44, 8
  s_cbranch_scc1 L_nfa0
  s_add_u32 s25, s25, 10223616
  buffer_load_dwordx3 v[64:66], v59, s[4:7], s25 offen
L_nfa0:
  s_setprio 1
  s_mov_b32 s24, 0
L_blkb0:
  s_cmp_ge_u32 s45, 8
  s_cbranch_scc1 L_v4b0
  s_cmp_eq_u32 s45, 7
  s_cbranch_scc1 L_w7b0
  s_cmp_eq_u32 s45, 6
  s_cbranch_scc1 L_w6b0
  s_cmp_eq_u32 s45, 5
  s_cbranch_scc1 L_w5b0
  s_cmp_eq_u32 s45, 4
  s_cbranch_scc1 L_w4b0
  s_cmp_eq_u32 s45, 3
  s_cbranch_scc1 L_w3b0
  s_cmp_eq_u32 s45, 2
  s_cbranch_scc1 L_w2b0
  s_cmp_eq_u32 s45, 0
  s_cbranch_scc1 L_doneb0
L_w1b0:
  v_and_b32 v120, 0xffff, v44
  v_lshlrev_b32 v47, 8, v46
  s_nop 0
  v_add_u32_dpp v76, v120, v55 quad_perm:[0,0,0,0] row_mask:0xf bank_mask:0xf
  ds_read_b64_tr_b16 v[84:85], v76 offset:0
  ds_read_b64_tr_b16 v[88:89], v76 offset:40960
  v_pk_ashrrev_i16 v120, 15, v46 op_sel_hi:[0,1]
  v_pk_ashrrev_i16 v121, 15, v47 op_sel_hi:[0,1]
  v_and_b32_dpp v76, v45, v120 row_newbcast:0 row_mask:0xf bank_mask:0xf
  v_and_b32_dpp v77, v45, v121 row_newbcast:1 row_mask:0xf bank_mask:0xf
  s_waitcnt lgkmcnt(1)
  s_nop 0
  v_mfma_f32_16x16x16_bf16 v[12:15], v[84:85], v[76:77], v[12:15]
  s_waitcnt lgkmcnt(0)
  v_mfma_f32_16x16x16_bf16 v[16:19], v[88:89], v[76:77], v[16:19]
  s_branch L_doneb0
L_w2b0:
  v_lshrrev_b32 v121, 16, v44
  v_and_b32 v120, 0xffff, v44
  v_lshlrev_b32 v47, 8, v46
  s_nop 0
  v_add_u32_dpp v76, v120, v55 quad_perm:[0,0,0,0] row_mask:0xf bank_mask:0xf
  v_add_u32_dpp v77, v121, v55 quad_perm:[0,0,0,0] row_mask:0xf bank_mask:0xf
  ds_read_b64_tr_b16 v[84:85], v76 offset:0
  ds_read_b64_tr_b16 v[86:87], v77 offset:0
  ds_read_b64_tr_b16 v[88:89], v76 offset:40960
  ds_read_b64_tr_b16 v[90:91], v77 offset:40960
  v_lshlrev_b64 v[118:119], 1, v[46:47]
  v_pk_ashrrev_i16 v120, 15, v46 op_sel_hi:[0,1]
  v_pk_ashrrev_i16 v121, 15, v47 op_sel_hi:[0,1]
  v_pk_ashrrev_i16 v122, 15, v118 op_sel_hi:[0,1]
  v_pk_ashrrev_i16 v123, 15, v119 op_sel_hi:[0,1]
  v_and_b32_dpp v76, v45, v120 row_newbcast:0 row_mask:0xf bank_mask:0xf
  v_and_b32_dpp v77, v45, v121 row_newbcast:1 row_mask:0xf bank_mask:0xf
  v_and_b32_dpp v78, v45, v122 row_newbcast:2 row_mask:0xf bank_mask:0xf
  v_and_b32_dpp v79, v45, v123 row_newbcast:3 row_mask:0xf bank_mask:0xf
  s_waitcnt lgkmcnt(2)
  s_nop 0
  v_mfma_f32_16x16x32_bf16 v[12:15], v[84:87], v[76:79], v[12:15]
  s_waitcnt lgkmcnt(0)
  v_mfma_f32_16x16x32_bf16 v[16:19], v[88:91], v[76:79], v[16:19]
  s_branch L_doneb0
L_w3b0:
  v_lshrrev_b32 v121, 16, v44
  v_and_b32 v120, 0xffff, v44
  v_lshlrev_b32 v47, 8, v46
  s_nop 0
  v_add_u32_dpp v76, v120, v55 quad_perm:[0,0,0,0] row_mask:0xf bank_mask:0xf
  v_add_u32_dpp v77, v121, v55 quad_perm:[0,0,0,0] row_mask:0xf bank_mask:0xf
  ds_read_b64_tr_b16 v[84:85], v76 offset:0
  ds_read_b64_tr_b16 v[86:87], v77 offset:0
  ds_read_b64_tr_b16 v[88:89], v76 offset:40960
  ds_read_b64_tr_b16 v[90:91], v77 offset:40960
  v_add_u32_dpp v78, v120, v55 quad_perm:[1,1,1,1] row_mask:0xf bank_mask:0xf
  ds_read_b64_tr_b16 v[92:93], v78 offset:0
  ds_read_b64_tr_b16 v[96:97], v78 offset:40960
  v_lshlrev_b64 v[118:119], 1, v[46:47]
  v_pk_ashrrev_i16 v120, 15, v46 op_sel_hi:[0,1]
  v_pk_ashrrev_i16 v121, 15, v47 op_sel_hi:[0,1]
  v_pk_ashrrev_i16 v122, 15, v118 op_sel_hi:[0,1]
  v_pk_ashrrev_i16 v123, 15, v119 op_sel_hi:[0,1]
  v_and_b32_dpp v76, v45, v120 row_newbcast:0 row_mask:0xf bank_mask:0xf
  v_and_b32_dpp v77, v45, v121 row_newbcast:1 row_mask:0xf bank_mask:0xf
  v_and_b32_dpp v78, v45, v122 row_newbcast:2 row_mask:0xf bank_mask:0xf
  v_and_b32_dpp v79, v45, v123 row_newbcast:3 row_mask:0xf bank_mask:0xf
  v_lshlrev_b64 v[116:117], 2, v[46:47]
  v_pk_ashrrev_i16 v120, 15, v116 op_sel_hi:[0,1]
  v_pk_ashrrev_i16 v121, 15, v117 op_sel_hi:[0,1]
  s_waitcnt lgkmcnt(4)
  v_mfma_f32_16x16x32_bf16 v[12:15], v[84:87], v[76:79], v[12:15]
  v_and_b32_dpp v80, v45, v120 row_newbcast:4 row_mask:0xf bank_mask:0xf
  v_and_b32_dpp v81, v45, v121 row_newbcast:5 row_mask:0xf bank_mask:0xf
  s_waitcnt lgkmcnt(2)
  v_mfma_f32_16x16x32_bf16 v[16:19], v[88:91], v[76:79], v[16:19]
  s_waitcnt lgkmcnt(1)
  s_nop 0
  v_mfma_f32_16x16x16_bf16 v[12:15], v[92:93], v[80:81], v[12:15]
  s_waitcnt lgkmcnt(0)
  v_mfma_f32_16x16x16_bf16 v[16:19], v[96:97], v[80:81], v[16:19]
  s_branch L_doneb0
L_w4b0:
  v_lshrrev_b32 v121, 16, v44
  v_and_b32 v120, 0xffff, v44
  v_lshlrev_b32 v47, 8, v46
  s_nop 0
  v_add_u32_dpp v76, v120, v55 quad_perm:[0,0,0,0] row_mask:0xf bank_mask:0xf
  v_add_u32_dpp v77, v121, v55 quad_perm:[0,0,0,0] row_mask:0xf bank_mask:0xf
  ds_read_b64_tr_b16 v[84:85], v76 offset:0
  ds_read_b64_tr_b16 v[86:87], v77 offset:0
  ds_read_b64_tr_b16 v[88:89], v76 offset:40960
  ds_read_b64_tr_b16 v[90:91], v77 offset:40960
  v_add_u32_dpp v78, v120, v55 quad_perm:[1,1,1,1] row_mask:0xf bank_mask:0xf
  v_add_u32_dpp v79, v121, v55 quad_perm:[1,1,1,1] row_mask:0xf bank_mask:0xf
  ds_read_b64_tr_b16 v[92:93], v78 offset:0
  ds_read_b64_tr_b16 v[94:95], v79 offset:0
  ds_read_b64_tr_b16 v[96:97], v78 offset:40960
  ds_read_b64_tr_b16 v[98:99], v79 offset:40960
  v_lshlrev_b64 v[118:119], 1, v[46:47]
  v_pk_ashrrev_i16 v120, 15, v46 op_sel_hi:[0,1]
  v_pk_ashrrev_i16 v121, 15, v47 op_sel_hi:[0,1]
  v_pk_ashrrev_i16 v122, 15, v118 op_sel_hi:[0,1]
  v_pk_ashrrev_i16 v123, 15, v119 op_sel_hi:[0,1]
  v_and_b32_dpp v76, v45, v120 row_newbcast:0 row_mask:0xf bank_mask:0xf
  v_and_b32_dpp v77, v45, v121 row_newbcast:1 row_mask:0xf bank_mask:0xf
  v_and_b32_dpp v78, v45, v122 row_newbcast:2 row_mask:0xf bank_mask:0xf
  v_and_b32_dpp v79, v45, v123 row_newbcast:3 row_mask:0xf bank_mask:0xf
  v_lshlrev_b64 v[116:117], 2, v[46:47]
  v_lshlrev_b64 v[118:119], 3, v[46:47]
  v_pk_ashrrev_i16 v120, 15, v116 op_sel_hi:[0,1]
  v_pk_ashrrev_i16 v121, 15, v117 op_sel_hi:[0,1]
  v_pk_ashrrev_i16 v122, 15, v118 op_sel_hi:[0,1]
  s_waitcnt lgkmcnt(6)
  v_mfma_f32_16x16x32_bf16 v[12:15], v[84:87], v[76:79], v[12:15]
  v_pk_ashrrev_i16 v123, 15, v119 op_sel_hi:[0,1]
  v_and_b32_dpp v80, v45, v120 row_newbcast:4 row_mask:0xf bank_mask:0xf
  v_and_b32_dpp v81, v45, v121 row_newbcast:5 row_mask:0xf bank_mask:0xf
  v_and_b32_dpp v82, v45, v122 row_newbcast:6 row_mask:0xf bank_mask:0xf
  v_and_b32_dpp v83, v45, v123 row_newbcast:7 row_mask:0xf bank_mask:0xf
  s_waitcnt lgkmcnt(4)
  v_mfma_f32_16x16x32_bf16 v[16:19], v[88:91], v[76:79], v[16:19]
  s_waitcnt lgkmcnt(2)
  s_nop 0
  v_mfma_f32_16x16x32_bf16 v[12:15], v[92:95], v[80:83], v[12:15]
  s_waitcnt lgkmcnt(0)
  v_mfma_f32_16x16x32_bf16 v[16:19], v[96:99], v[80:83], v[16:19]
  s_branch L_doneb0
L_w5b0:
  v_lshrrev_b32 v121, 16, v44
  v_and_b32 v120, 0xffff, v44
  v_lshlrev_b32 v47, 8, v46
  s_nop 0
  v_add_u32_dpp v76, v120, v55 quad_perm:[0,0,0,0] row_mask:0xf bank_mask:0xf
  v_add_u32_dpp v77, v121, v55 quad_perm:[0,0,0,0] row_mask:0xf bank_mask:0xf
  ds_read_b64_tr_b16 v[84:85], v76 offset:0
  ds_read_b64_tr_b16 v[86:87], v77 offset:0
  ds_read_b64_tr_b16 v[88:89], v76 offset:40960
  ds_read_b64_tr_b16 v[90:91], v77 offset:40960
  v_add_u32_dpp v78, v120, v55 quad_perm:[1,1,1,1] row_mask:0xf bank_mask:0xf
  v_add_u32_dpp v79, v121, v55 quad_perm:[1,1,1,1] row_mask:0xf bank_mask:0xf
  ds_read_b64_tr_b16 v[92:93], v78 offset:0
  ds_read_b64_tr_b16 v[94:95], v79 offset:0
  ds_read_b64_tr_b16 v[96:97], v78 offset:40960
  ds_read_b64_tr_b16 v[98:99], v79 offset:40960
  v_add_u32_dpp v80, v120, v55 quad_perm:[2,2,2,2] row_mask:0xf bank_mask:0xf
  ds_read_b64_tr_b16 v[100:101], v80 offset:0
  ds_read_b64_tr_b16 v[104:105], v80 offset:40960
  v_lshlrev_b64 v[118:119], 1, v[46:47]
  v_pk_ashrrev_i16 v120, 15, v46 op_sel_hi:[0,1]
  v_pk_ashrrev_i16 v121, 15, v47 op_sel_hi:[0,1]
  v_pk_ashrrev_i16 v122, 15, v118 op_sel_hi:[0,1]
  v_pk_ashrrev_i16 v123, 15, v119 op_sel_hi:[0,1]
  v_and_b32_dpp v76, v45, v120 row_newbcast:0 row_mask:0xf bank_mask:0xf
  v_and_b32_dpp v77, v45, v121 row_newbcast:1 row_mask:0xf bank_mask:0xf
  v_and_b32_dpp v78, v45, v122 row_newbcast:2 row_mask:0xf bank_mask:0xf
  v_and_b32_dpp v79, v45, v123 row_newbcast:3 row_mask:0xf bank_mask:0xf
  v_lshlrev_b64 v[116:117], 2, v[46:47]
  v_lshlrev_b64 v[118:119], 3, v[46:47]
  v_pk_ashrrev_i16 v120, 15, v116 op_sel_hi:[0,1]
  v_pk_ashrrev_i16 v121, 15, v117 op_sel_hi:[0,1]
  v_pk_ashrrev_i16 v122, 15, v118 op_sel_hi:[0,1]
  s_waitcnt lgkmcnt(8)
  v_mfma_f32_16x16x32_bf16 v[12:15], v[84:87], v[76:79], v[12:15]
  v_pk_ashrrev_i16 v123, 15, v119 op_sel_hi:[0,1]
  v_and_b32_dpp v80, v45, v120 row_newbcast:4 row_mask:0xf bank_mask:0xf
  v_and_b32_dpp v81, v45, v121 row_newbcast:5 row_mask:0xf bank_mask:0xf
  v_and_b32_dpp v82, v45, v122 row_newbcast:6 row_mask:0xf bank_mask:0xf
  v_and_b32_dpp v83, v45, v123 row_newbcast:7 row_mask:0xf bank_mask:0xf
  s_waitcnt lgkmcnt(6)
  v_mfma_f32_16x16x32_bf16 v[16:19], v[88:91], v[76:79], v[16:19]
  v_lshlrev_b64 v[116:117], 4, v[46:47]
  v_pk_ashrrev_i16 v120, 15, v116 op_sel_hi:[0,1]
  v_pk_ashrrev_i16 v121, 15, v117 op_sel_hi:[0,1]
  s_waitcnt lgkmcnt(4)
  v_mfma_f32_16x16x32_bf16 v[12:15], v[92:95], v[80:83], v[12:15]
  v_and_b32_dpp v76, v45, v120 row_newbcast:8 row_mask:0xf bank_mask:0xf
  v_and_b32_dpp v77, v45, v121 row_newbcast:9 row_mask:0xf bank_mask:0xf
  s_waitcnt lgkmcnt(2)
  v_mfma_f32_16x16x32_bf16 v[16:19], v[96:99], v[80:83], v[16:19]
  s_waitcnt lgkmcnt(1)
  s_nop 0
  v_mfma_f32_16x16x16_bf16 v[12:15], v[100:101], v[76:77], v[12:15]
  s_waitcnt lgkmcnt(0)
  v_mfma_f32_16x16x16_bf16 v[16:19], v[104:105], v[76:77], v[16:19]
  s_branch L_doneb0
L_w6b0:
  v_lshrrev_b32 v121, 16, v44
  v_and_b32 v120, 0xffff, v44
  v_lshlrev_b32 v47, 8, v46
  s_nop 0
  v_add_u32_dpp v76, v120, v55 quad_perm:[0,0,0,0] row_mask:0xf bank_mask:0xf
  v_add_u32_dpp v77, v121, v55 quad_perm:[0,0,0,0] row_mask:0xf bank_mask:0xf
  ds_read_b64_tr_b16 v[84:85], v76 offset:0
  ds_read_b64_tr_b16 v[86:87], v77 offset:0
  ds_read_b64_tr_b16 v[88:89], v76 offset:40960
  ds_read_b64_tr_b16 v[90:91], v77 offset:40960
  v_add_u32_dpp v78, v120, v55 quad_perm:[1,1,1,1] row_mask:0xf bank_mask:0xf
  v_add_u32_dpp v79, v121, v55 quad_perm:[1,1,1,1] row_mask:0xf bank_mask:0xf
  ds_read_b64_tr_b16 v[92:93], v78 offset:0
  ds_read_b64_tr_b16 v[94:95], v79 offset:0
  ds_read_b64_tr_b16 v[96:97], v78 offset:40960
  ds_read_b64_tr_b16 v[98:99], v79 offset:40960
  v_add_u32_dpp v80, v120, v55 quad_perm:[2,2,2,2] row_mask:0xf bank_mask:0xf
  v_add_u32_dpp v81, v121, v55 quad_perm:[2,2,2,2] row_mask:0xf bank_mask:0xf
  ds_read_b64_tr_b16 v[100:101], v80 offset:0
  ds_read_b64_tr_b16 v[102:103], v81 offset:0
  ds_read_b64_tr_b16 v[104:105], v80 offset:40960
  ds_read_b64_tr_b16 v[106:107], v81 offset:40960
  v_lshlrev_b64 v[118:119], 1, v[46:47]
  v_pk_ashrrev_i16 v120, 15, v46 op_sel_hi:[0,1]
  v_pk_ashrrev_i16 v121, 15, v47 op_sel_hi:[0,1]
  v_pk_ashrrev_i16 v122, 15, v118 op_sel_hi:[0,1]
  v_pk_ashrrev_i16 v123, 15, v119 op_sel_hi:[0,1]
  v_and_b32_dpp v76, v45, v120 row_newbcast:0 row_mask:0xf bank_mask:0xf
  v_and_b32_dpp v77, v45, v121 row_newbcast:1 row_mask:0xf bank_mask:0xf
  v_and_b32_dpp v78, v45, v122 row_newbcast:2 row_mask:0xf bank_mask:0xf
  v_and_b32_dpp v79, v45, v123 row_newbcast:3 row_mask:0xf bank_mask:0xf
  v_lshlrev_b64 v[116:117], 2, v[46:47]
  v_lshlrev_b64 v[118:119], 3, v[46:47]
  v_pk_ashrrev_i16 v120, 15, v116 op_sel_hi:[0,1]
  v_pk_ashrrev_i16 v121, 15, v117 op_sel_hi:[0,1]
  v_pk_ashrrev_i16 v122, 15, v118 op_sel_hi:[0,1]
  s_waitcnt lgkmcnt(10)
  v_mfma_f32_16x16x32_bf16 v[12:15], v[84:87], v[76:79], v[12:15]
  v_pk_ashrrev_i16 v123, 15, v119 op_sel_hi:[0,1]
  v_and_b32_dpp v80, v45, v120 row_newbcast:4 row_mask:0xf bank_mask:0xf
  v_and_b32_dpp v81, v45, v121 row_newbcast:5 row_mask:0xf bank_mask:0xf
  v_and_b32_dpp v82, v45, v122 row_newbcast:6 row_mask:0xf bank_mask:0xf
  v_and_b32_dpp v83, v45, v123 row_newbcast:7 row_mask:0xf bank_mask:0xf
  s_waitcnt lgkmcnt(8)
  v_mfma_f32_16x16x32_bf16 v[16:19], v[88:91], v[76:79], v[16:19]
  v_lshlrev_b64 v[116:117], 4, v[46:47]
  v_lshlrev_b64 v[118:119], 5, v[46:47]
  v_pk_ashrrev_i16 v120, 15, v116 op_sel_hi:[0,1]
  v_pk_ashrrev_i16 v121, 15, v117 op_sel_hi:[0,1]
  v_pk_ashrrev_i16 v122, 15, v118 op_sel_hi:[0,1]
  s_waitcnt lgkmcnt(6)
  v_mfma_f32_16x16x32_bf16 v[12:15], v[92:95], v[80:83], v[12:15]
  v_pk_ashrrev_i16 v123, 15, v119 op_sel_hi:[0,1]
  v_and_b32_dpp v76, v45, v120 row_newbcast:8 row_mask:0xf bank_mask:0xf
  v_and_b32_dpp v77, v45, v121 row_newbcast:9 row_mask:0xf bank_mask:0xf
  v_and_b32_dpp v78, v45, v122 row_newbcast:10 row_mask:0xf bank_mask:0xf
  v_and_b32_dpp v79, v45, v123 row_newbcast:11 row_mask:0xf bank_mask:0xf
  s_waitcnt lgkmcnt(4)
  v_mfma_f32_16x16x32_bf16 v[16:19], v[96:99], v[80:83], v[16:19]
  s_waitcnt lgkmcnt(2)
  s_nop 0
  v_mfma_f32_16x16x32_bf16 v[12:15], v[100:103], v[76:79], v[12:15]
  s_waitcnt lgkmcnt(0)
  v_mfma_f32_16x16x32_bf16 v[16:19], v[104:107], v[76:79], v[16:19]
  s_branch L_doneb0
L_w7b0:
  v_lshrrev_b32 v121, 16, v44
  v_and_b32 v120, 0xffff, v44
  v_lshlrev_b32 v47, 8, v46
  s_nop 0
  v_add_u32_dpp v76, v120, v55 quad_perm:[0,0,0,0] row_mask:0xf bank_mask:0xf
  v_add_u32_dpp v77, v121, v55 quad_perm:[0,0,0,0] row_mask:0xf bank_mask:0xf
  ds_read_b64_tr_b16 v[84:85], v76 offset:0
  ds_read_b64_tr_b16 v[86:87], v77 offset:0
  ds_read_b64_tr_b16 v[88:89], v76 offset:40960
  ds_read_b64_tr_b16 v[90:91], v77 offset:40960
  v_add_u32_dpp v78, v120, v55 quad_perm:[1,1,1,1] row_mask:0xf bank_mask:0xf
  v_add_u32_dpp v79, v121, v55 quad_perm:[1,1,1,1] row_mask:0xf bank_mask:0xf
  ds_read_b64_tr_b16 v[92:93], v78 offset:0
  ds_read_b64_tr_b16 v[94:95], v79 offset:0
  ds_read_b64_tr_b16 v[96:97], v78 offset:40960
  ds_read_b64_tr_b16 v[98:99], v79 offset:40960
  v_add_u32_dpp v80, v120, v55 quad_perm:[2,2,2,2] row_mask:0xf bank_mask:0xf
  v_add_u32_dpp v81, v121, v55 quad_perm:[2,2,2,2] row_mask:0xf bank_mask:0xf
  ds_read_b64_tr_b16 v[100:101], v80 offset:0
  ds_read_b64_tr_b16 v[102:103], v81 offset:0
  ds_read_b64_tr_b16 v[104:105], v80 offset:40960
  ds_read_b64_tr_b16 v[106:107], v81 offset:40960
  v_add_u32_dpp v82, v120, v55 quad_perm:[3,3,3,3] row_mask:0xf bank_mask:0xf
  ds_read_b64_tr_b16 v[108:109], v82 offset:0
  ds_read_b64_tr_b16 v[112:113], v82 offset:40960
  v_lshlrev_b64 v[118:119], 1, v[46:47]
  v_pk_ashrrev_i16 v120, 15, v46 op_sel_hi:[0,1]
  v_pk_ashrrev_i16 v121, 15, v47 op_sel_hi:[0,1]
  v_pk_ashrrev_i16 v122, 15, v118 op_sel_hi:[0,1]
  v_pk_ashrrev_i16 v123, 15, v119 op_sel_hi:[0,1]
  v_and_b32_dpp v76, v45, v120 row_newbcast:0 row_mask:0xf bank_mask:0xf
  v_and_b32_dpp v77, v45, v121 row_newbcast:1 row_mask:0xf bank_mask:0xf
  v_and_b32_dpp v78, v45, v122 row_newbcast:2 row_mask:0xf bank_mask:0xf
  v_and_b32_dpp v79, v45, v123 row_newbcast:3 row_mask:0xf bank_mask:0xf
  v_lshlrev_b64 v[116:117], 2, v[46:47]
  v_lshlrev_b64 v[118:119], 3, v[46:47]
  v_pk_ashrrev_i16 v120, 15, v116 op_sel_hi:[0,1]
  v_pk_ashrrev_i16 v121, 15, v117 op_sel_hi:[0,1]
  v_pk_ashrrev_i16 v122, 15, v118 op_sel_hi:[0,1]
  s_waitcnt lgkmcnt(12)
  v_mfma_f32_16x16x32_bf16 v[12:15], v[84:87], v[76:79], v[12:15]
  v_pk_ashrrev_i16 v123, 15, v119 op_sel_hi:[0,1]
  v_and_b32_dpp v80, v45, v120 row_newbcast:4 row_mask:0xf bank_mask:0xf
  v_and_b32_dpp v81, v45, v121 row_newbcast:5 row_mask:0xf bank_mask:0xf
  v_and_b32_dpp v82, v45, v122 row_newbcast:6 row_mask:0xf bank_mask:0xf
  v_and_b32_dpp v83, v45, v123 row_newbcast:7 row_mask:0xf bank_mask:0xf
  s_waitcnt lgkmcnt(10)
  v_mfma_f32_16x16x32_bf16 v[16:19], v[88:91], v[76:79], v[16:19]
  v_lshlrev_b64 v[116:117], 4, v[46:47]
  v_lshlrev_b64 v[118:119], 5, v[46:47]
  v_pk_ashrrev_i16 v120, 15, v116 op_sel_hi:[0,1]
  v_pk_ashrrev_i16 v121, 15, v117 op_sel_hi:[0,1]
  v_pk_ashrrev_i16 v122, 15, v118 op_sel_hi:[0,1]
  s_waitcnt lgkmcnt(8)
  v_mfma_f32_16x16x32_bf16 v[12:15], v[92:95], v[80:83], v[12:15]
  v_pk_ashrrev_i16 v123, 15, v119 op_sel_hi:[0,1]
  v_and_b32_dpp v76, v45, v120 row_newbcast:8 row_mask:0xf bank_mask:0xf
  v_and_b32_dpp v77, v45, v121 row_newbcast:9 row_mask:0xf bank_mask:0xf
  v_and_b32_dpp v78, v45, v122 row_newbcast:10 row_mask:0xf bank_mask:0xf
  v_and_b32_dpp v79, v45, v123 row_newbcast:11 row_mask:0xf bank_mask:0xf
  s_waitcnt lgkmcnt(6)
  v_mfma_f32_16x16x32_bf16 v[16:19], v[96:99], v[80:83], v[16:19]
  v_lshlrev_b64 v[116:117], 6, v[46:47]
  v_pk_ashrrev_i16 v120, 15, v116 op_sel_hi:[0,1]
  v_pk_ashrrev_i16 v121, 15, v117 op_sel_hi:[0,1]
  s_waitcnt lgkmcnt(4)
  v_mfma_f32_16x16x32_bf16 v[12:15], v[100:103], v[76:79], v[12:15]
  v_and_b32_dpp v80, v45, v120 row_newbcast:12 row_mask:0xf bank_mask:0xf
  v_and_b32_dpp v81, v45, v121 row_newbcast:13 row_mask:0xf bank_mask:0xf
  s_waitcnt lgkmcnt(2)
  v_mfma_f32_16x16x32_bf16 v[16:19], v[104:107], v[76:79], v[16:19]
  s_waitcnt lgkmcnt(1)
  s_nop 0
  v_mfma_f32_16x16x16_bf16 v[12:15], v[108:109], v[80:81], v[12:15]
  s_waitcnt lgkmcnt(0)
  v_mfma_f32_16x16x16_bf16 v[16:19], v[112:113], v[80:81], v[16:19]
  s_branch L_doneb0
L_slowb0:
  s_mul_i32 s25, s24, 10223616
  s_add_u32 s25, s25, s17
  s_add_u32 s25, s25, 119808
  buffer_load_dwordx3 v[44:46], v59, s[4:7], s25 offen
  s_waitcnt vmcnt(0)
  s_branch L_blkb0
L_moreb0:
  s_add_u32 s24, s24, 1
  s_cmp_lg_u32 s24, 1
  s_cbranch_scc1 L_slowb0
  v_mov_b32 v44, v68
  v_mov_b32 v45, v69
  v_mov_b32 v46, v70
  s_branch L_blkb0
L_v4b0:
  v_lshrrev_b32 v121, 16, v44
  v_and_b32 v120, 0xffff, v44
  v_lshlrev_b32 v47, 8, v46
  s_nop 0
  v_add_u32_dpp v76, v120, v55 quad_perm:[0,0,0,0] row_mask:0xf bank_mask:0xf
  v_add_u32_dpp v77, v121, v55 quad_perm:[0,0,0,0] row_mask:0xf bank_mask:0xf
  ds_read_b64_tr_b16 v[84:85], v76 offset:0
  ds_read_b64_tr_b16 v[86:87], v77 offset:0
  ds_read_b64_tr_b16 v[88:89], v76 offset:40960
  ds_read_b64_tr_b16 v[90:91], v77 offset:40960
  v_add_u32_dpp v78, v120, v55 quad_perm:[1,1,1,1] row_mask:0xf bank_mask:0xf
  v_add_u32_dpp v79, v121, v55 quad_perm:[1,1,1,1] row_mask:0xf bank_mask:0xf
  ds_read_b64_tr_b16 v[92:93], v78 offset:0
  ds_read_b64_tr_b16 v[94:95], v79 offset:0
  ds_read_b64_tr_b16 v[96:97], v78 offset:40960
  ds_read_b64_tr_b16 v[98:99], v79 offset:40960
  v_add_u32_dpp v80, v120, v55 quad_perm:[2,2,2,2] row_mask:0xf bank_mask:0xf
  v_add_u32_dpp v81, v121, v55 quad_perm:[2,2,2,2] row_mask:0xf bank_mask:0xf
  ds_read_b64_tr_b16 v[100:101], v80 offset:0
  ds_read_b64_tr_b16 v[102:103], v81 offset:0
  ds_read_b64_tr_b16 v[104:105], v80 offset:40960
  ds_read_b64_tr_b16 v[106:107], v81 offset:40960
  v_add_u32_dpp v82, v120, v55 quad_perm:[3,3,3,3] row_mask:0xf bank_mask:0xf
  v_add_u32_dpp v83, v121, v55 quad_perm:[3,3,3,3] row_mask:0xf bank_mask:0xf
  ds_read_b64_tr_b16 v[108:109], v82 offset:0
  ds_read_b64_tr_b16 v[110:111], v83 offset:0
  ds_read_b64_tr_b16 v[112:113], v82 offset:40960
  ds_read_b64_tr_b16 v[114:115], v83 offset:40960
  v_lshlrev_b64 v[118:119], 1, v[46:47]
  v_pk_ashrrev_i16 v120, 15, v46 op_sel_hi:[0,1]
  v_pk_ashrrev_i16 v121, 15, v47 op_sel_hi:[0,1]
  v_pk_ashrrev_i16 v122, 15, v118 op_sel_hi:[0,1]
  v_pk_ashrrev_i16 v123, 15, v119 op_sel_hi:[0,1]
  v_and_b32_dpp v76, v45, v120 row_newbcast:0 row_mask:0xf bank_mask:0xf
  v_and_b32_dpp v77, v45, v121 row_newbcast:1 row_mask:0xf bank_mask:0xf
  v_and_b32_dpp v78, v45, v122 row_newbcast:2 row_mask:0xf bank_mask:0xf
  v_and_b32_dpp v79, v45, v123 row_newbcast:3 row_mask:0xf bank_mask:0xf
  v_lshlrev_b64 v[116:117], 2, v[46:47]
  v_lshlrev_b64 v[118:119], 3, v[46:47]
  v_pk_ashrrev_i16 v120, 15, v116 op_sel_hi:[0,1]
  v_pk_ashrrev_i16 v121, 15, v117 op_sel_hi:[0,1]
  v_pk_ashrrev_i16 v122, 15, v118 op_sel_hi:[0,1]
  s_waitcnt lgkmcnt(14)
  v_mfma_f32_16x16x32_bf16 v[12:15], v[84:87], v[76:79], v[12:15]
  v_pk_ashrrev_i16 v123, 15, v119 op_sel_hi:[0,1]
  v_and_b32_dpp v80, v45, v120 row_newbcast:4 row_mask:0xf bank_mask:0xf
  v_and_b32_dpp v81, v45, v121 row_newbcast:5 row_mask:0xf bank_mask:0xf
  v_and_b32_dpp v82, v45, v122 row_newbcast:6 row_mask:0xf bank_mask:0xf
  v_and_b32_dpp v83, v45, v123 row_newbcast:7 row_mask:0xf bank_mask:0xf
  s_waitcnt lgkmcnt(12)
  v_mfma_f32_16x16x32_bf16 v[16:19], v[88:91], v[76:79], v[16:19]
  v_lshlrev_b64 v[116:117], 4, v[46:47]
  v_lshlrev_b64 v[118:119], 5, v[46:47]
  v_pk_ashrrev_i16 v120, 15, v116 op_sel_hi:[0,1]
  v_pk_ashrrev_i16 v121, 15, v117 op_sel_hi:[0,1]
  v_pk_ashrrev_i16 v122, 15, v118 op_sel_hi:[0,1]
  s_waitcnt lgkmcnt(10)
  v_mfma_f32_16x16x32_bf16 v[12:15], v[92:95], v[80:83], v[12:15]
  v_pk_ashrrev_i16 v123, 15, v119 op_sel_hi:[0,1]
  v_and_b32_dpp v76, v45, v120 row_newbcast:8 row_mask:0xf bank_mask:0xf
  v_and_b32_dpp v77, v45, v121 row_newbcast:9 row_mask:0xf bank_mask:0xf
  v_and_b32_dpp v78, v45, v122 row_newbcast:10 row_mask:0xf bank_mask:0xf
  v_and_b32_dpp v79, v45, v123 row_newbcast:11 row_mask:0xf bank_mask:0xf
  s_waitcnt lgkmcnt(8)
  v_mfma_f32_16x16x32_bf16 v[16:19], v[96:99], v[80:83], v[16:19]
  v_lshlrev_b64 v[116:117], 6, v[46:47]
  v_lshlrev_b64 v[118:119], 7, v[46:47]
  v_pk_ashrrev_i16 v120, 15, v116 op_sel_hi:[0,1]
  v_pk_ashrrev_i16 v121, 15, v117 op_sel_hi:[0,1]
  v_pk_ashrrev_i16 v122, 15, v118 op_sel_hi:[0,1]
  s_waitcnt lgkmcnt(6)
  v_mfma_f32_16x16x32_bf16 v[12:15], v[100:103], v[76:79], v[12:15]
  v_pk_ashrrev_i16 v123, 15, v119 op_sel_hi:[0,1]
  v_and_b32_dpp v80, v45, v120 row_newbcast:12 row_mask:0xf bank_mask:0xf
  v_and_b32_dpp v81, v45, v121 row_newbcast:13 row_mask:0xf bank_mask:0xf
  v_and_b32_dpp v82, v45, v122 row_newbcast:14 row_mask:0xf bank_mask:0xf
  v_and_b32_dpp v83, v45, v123 row_newbcast:15 row_mask:0xf bank_mask:0xf
  s_waitcnt lgkmcnt(4)
  v_mfma_f32_16x16x32_bf16 v[16:19], v[104:107], v[76:79], v[16:19]
  s_waitcnt lgkmcnt(2)
  s_nop 0
  v_mfma_f32_16x16x32_bf16 v[12:15], v[108:111], v[80:83], v[12:15]
  s_waitcnt lgkmcnt(0)
  v_mfma_f32_16x16x32_bf16 v[16:19], v[112:115], v[80:83], v[16:19]
  s_sub_u32 s45, s45, 8
  s_cmp_lg_u32 s45, 0
  s_cbranch_scc1 L_moreb0
L_doneb0:
  s_add_u32 s26, s16, 18
  s_add_u32 s25, s17, 121344
  v_readlane_b32 s45, v63, s26
  buffer_load_dwordx3 v[44:46], v59, s[4:7], s25 offen
  s_cmp_le_u32 s45, 8
  s_cbranch_scc1 L_nfb0
  s_add_u32 s25, s25, 10223616
  buffer_load_dwordx3 v[68:70], v59, s[4:7], s25 offen
L_nfb0:
  s_cmp_ge_u32 s16, 12
  s_cbranch_scc1 L_epi
  s_add_u32 s16, s16, 1
  s_add_u32 s17, s17, 768
  v_xor_b32 v55, 0x14000, v55
  s_waitcnt vmcnt(2)
  s_barrier
L_phase1:
  s_setprio 3
  s_mov_b32 s24, 0
L_blkc1:
  s_cmp_ge_u32 s22, 8
  s_cbranch_scc1 L_v4c1
  s_cmp_eq_u32 s22, 7
  s_cbranch_scc1 L_w7c1
  s_cmp_eq_u32 s22, 6
  s_cbranch_scc1 L_w6c1
  s_cmp_eq_u32 s22, 5
  s_cbranch_scc1 L_w5c1
  s_cmp_eq_u32 s22, 4
  s_cbranch_scc1 L_w4c1
  s_cmp_eq_u32 s22, 3
  s_cbranch_scc1 L_w3c1
  s_cmp_eq_u32 s22, 2
  s_cbranch_scc1 L_w2c1
  s_cmp_eq_u32 s22, 0
  s_cbranch_scc1 L_donec1
L_w1c1:
  v_and_b32 v120, 0xffff, v36
  v_lshlrev_b32 v39, 8, v38
  s_nop 0
  v_add_u32_dpp v76, v120, v55 quad_perm:[0,0,0,0] row_mask:0xf bank_mask:0xf
  ds_read_b64_tr_b16 v[84:85], v76 offset:0
  ds_read_b64_tr_b16 v[88:89], v76 offset:40960
  v_pk_ashrrev_i16 v120, 15, v38 op_sel_hi:[0,1]
  v_pk_ashrrev_i16 v121, 15, v39 op_sel_hi:[0,1]
  v_and_b32_dpp v76, v37, v120 row_newbcast:0 row_mask:0xf bank_mask:0xf
  v_and_b32_dpp v77, v37, v121 row_newbcast:1 row_mask:0xf bank_mask:0xf
  s_waitcnt lgkmcnt(1)
  s_nop 0
  v_mfma_f32_16x16x16_bf16 v[20:23], v[84:85], v[76:77], v[20:23]
  s_waitcnt lgkmcnt(0)
  v_mfma_f32_16x16x16_bf16 v[24:27], v[88:89], v[76:77], v[24:27]
  s_branch L_donec1
L_w2c1:
  v_lshrrev_b32 v121, 16, v36
  v_and_b32 v120, 0xffff, v36
  v_lshlrev_b32 v39, 8, v38
  s_nop 0
  v_add_u32_dpp v76, v120, v55 quad_perm:[0,0,0,0] row_mask:0xf bank_mask:0xf
  v_add_u32_dpp v77, v121, v55 quad_perm:[0,0,0,0] row_mask:0xf bank_mask:0xf
  ds_read_b64_tr_b16 v[84:85], v76 offset:0
  ds_read_b64_tr_b16 v[86:87], v77 offset:0
  ds_read_b64_tr_b16 v[88:89], v76 offset:40960
  ds_read_b64_tr_b16 v[90:91], v77 offset:40960
  v_lshlrev_b64 v[118:119], 1, v[38:39]
  v_pk_ashrrev_i16 v120, 15, v38 op_sel_hi:[0,1]
  v_pk_ashrrev_i16 v121, 15, v39 op_sel_hi:[0,1]
  v_pk_ashrrev_i16 v122, 15, v118 op_sel_hi:[0,1]
  v_pk_ashrrev_i16 v123, 15, v119 op_sel_hi:[0,1]
  v_and_b32_dpp v76, v37, v120 row_newbcast:0 row_mask:0xf bank_mask:0xf
  v_and_b32_dpp v77, v37, v121 row_newbcast:1 row_mask:0xf bank_mask:0xf
  v_and_b32_dpp v78, v37, v122 row_newbcast:2 row_mask:0xf bank_mask:0xf
  v_and_b32_dpp v79, v37, v123 row_newbcast:3 row_mask:0xf bank_mask:0xf
  s_waitcnt lgkmcnt(2)
  s_nop 0
  v_mfma_f32_16x16x32_bf16 v[20:23], v[84:87], v[76:79], v[20:23]
  s_waitcnt lgkmcnt(0)
  v_mfma_f32_16x16x32_bf16 v[24:27], v[88:91], v[76:79], v[24:27]
  s_branch L_donec1
L_w3c1:
  v_lshrrev_b32 v121, 16, v36
  v_and_b32 v120, 0xffff, v36
  v_lshlrev_b32 v39, 8, v38
  s_nop 0
  v_add_u32_dpp v76, v120, v55 quad_perm:[0,0,0,0] row_mask:0xf bank_mask:0xf
  v_add_u32_dpp v77, v121, v55 quad_perm:[0,0,0,0] row_mask:0xf bank_mask:0xf
  ds_read_b64_tr_b16 v[84:85], v76 offset:0
  ds_read_b64_tr_b16 v[86:87], v77 offset:0
  ds_read_b64_tr_b16 v[88:89], v76 offset:40960
  ds_read_b64_tr_b16 v[90:91], v77 offset:40960
  v_add_u32_dpp v78, v120, v55 quad_perm:[1,1,1,1] row_mask:0xf bank_mask:0xf
  ds_read_b64_tr_b16 v[92:93], v78 offset:0
  ds_read_b64_tr_b16 v[96:97], v78 offset:40960
  v_lshlrev_b64 v[118:119], 1, v[38:39]
  v_pk_ashrrev_i16 v120, 15, v38 op_sel_hi:[0,1]
  v_pk_ashrrev_i16 v121, 15, v39 op_sel_hi:[0,1]
  v_pk_ashrrev_i16 v122, 15, v118 op_sel_hi:[0,1]
  v_pk_ashrrev_i16 v123, 15, v119 op_sel_hi:[0,1]
  v_and_b32_dpp v76, v37, v120 row_newbcast:0 row_mask:0xf bank_mask:0xf
  v_and_b32_dpp v77, v37, v121 row_newbcast:1 row_mask:0xf bank_mask:0xf
  v_and_b32_dpp v78, v37, v122 row_newbcast:2 row_mask:0xf bank_mask:0xf
  v_and_b32_dpp v79, v37, v123 row_newbcast:3 row_mask:0xf bank_mask:0xf
  v_lshlrev_b64 v[116:117], 2, v[38:39]
  v_pk_ashrrev_i16 v120, 15, v116 op_sel_hi:[0,1]
  v_pk_ashrrev_i16 v121, 15, v117 op_sel_hi:[0,1]
  s_waitcnt lgkmcnt(4)
  v_mfma_f32_16x16x32_bf16 v[20:23], v[84:87], v[76:79], v[20:23]
  v_and_b32_dpp v80, v37, v120 row_newbcast:4 row_mask:0xf bank_mask:0xf
  v_and_b32_dpp v81, v37, v121 row_newbcast:5 row_mask:0xf bank_mask:0xf
  s_waitcnt lgkmcnt(2)
  v_mfma_f32_16x16x32_bf16 v[24:27], v[88:91], v[76:79], v[24:27]
  s_waitcnt lgkmcnt(1)
  s_nop 0
  v_mfma_f32_16x16x16_bf16 v[20:23], v[92:93], v[80:81], v[20:23]
  s_waitcnt lgkmcnt(0)
  v_mfma_f32_16x16x16_bf16 v[24:27], v[96:97], v[80:81], v[24:27]
  s_branch L_donec1
L_w4c1:
  v_lshrrev_b32 v121, 16, v36
  v_and_b32 v120, 0xffff, v36
  v_lshlrev_b32 v39, 8, v38
  s_nop 0
  v_add_u32_dpp v76, v120, v55 quad_perm:[0,0,0,0] row_mask:0xf bank_mask:0xf
  v_add_u32_dpp v77, v121, v55 quad_perm:[0,0,0,0] row_mask:0xf bank_mask:0xf
  ds_read_b64_tr_b16 v[84:85], v76 offset:0
  ds_read_b64_tr_b16 v[86:87], v77 offset:0
  ds_read_b64_tr_b16 v[88:89], v76 offset:40960
  ds_read_b64_tr_b16 v[90:91], v77 offset:40960
  v_add_u32_dpp v78, v120, v55 quad_perm:[1,1,1,1] row_mask:0xf bank_mask:0xf
  v_add_u32_dpp v79, v121, v55 quad_perm:[1,1,1,1] row_mask:0xf bank_mask:0xf
  ds_read_b64_tr_b16 v[92:93], v78 offset:0
  ds_read_b64_tr_b16 v[94:95], v79 offset:0
  ds_read_b64_tr_b16 v[96:97], v78 offset:40960
  ds_read_b64_tr_b16 v[98:99], v79 offset:40960
  v_lshlrev_b64 v[118:119], 1, v[38:39]
  v_pk_ashrrev_i16 v120, 15, v38 op_sel_hi:[0,1]
  v_pk_ashrrev_i16 v121, 15, v39 op_sel_hi:[0,1]
  v_pk_ashrrev_i16 v122, 15, v118 op_sel_hi:[0,1]
  v_pk_ashrrev_i16 v123, 15, v119 op_sel_hi:[0,1]
  v_and_b32_dpp v76, v37, v120 row_newbcast:0 row_mask:0xf bank_mask:0xf
  v_and_b32_dpp v77, v37, v121 row_newbcast:1 row_mask:0xf bank_mask:0xf
  v_and_b32_dpp v78, v37, v122 row_newbcast:2 row_mask:0xf bank_mask:0xf
  v_and_b32_dpp v79, v37, v123 row_newbcast:3 row_mask:0xf bank_mask:0xf
  v_lshlrev_b64 v[116:117], 2, v[38:39]
  v_lshlrev_b64 v[118:119], 3, v[38:39]
  v_pk_ashrrev_i16 v120, 15, v116 op_sel_hi:[0,1]
  v_pk_ashrrev_i16 v121, 15, v117 op_sel_hi:[0,1]
  v_pk_ashrrev_i16 v122, 15, v118 op_sel_hi:[0,1]
  s_waitcnt lgkmcnt(6)
  v_mfma_f32_16x16x32_bf16 v[20:23], v[84:87], v[76:79], v[20:23]
  v_pk_ashrrev_i16 v123, 15, v119 op_sel_hi:[0,1]
  v_and_b32_dpp v80, v37, v120 row_newbcast:4 row_mask:0xf bank_mask:0xf
  v_and_b32_dpp v81, v37, v121 row_newbcast:5 row_mask:0xf bank_mask:0xf
  v_and_b32_dpp v82, v37, v122 row_newbcast:6 row_mask:0xf bank_mask:0xf
  v_and_b32_dpp v83, v37, v123 row_newbcast:7 row_mask:0xf bank_mask:0xf
  s_waitcnt lgkmcnt(4)
  v_mfma_f32_16x16x32_bf16 v[24:27], v[88:91], v[76:79], v[24:27]
  s_waitcnt lgkmcnt(2)
  s_nop 0
  v_mfma_f32_16x16x32_bf16 v[20:23], v[92:95], v[80:83], v[20:23]
  s_waitcnt lgkmcnt(0)
  v_mfma_f32_16x16x32_bf16 v[24:27], v[96:99], v[80:83], v[24:27]
  s_branch L_donec1
L_w5c1:
  v_lshrrev_b32 v121, 16, v36
  v_and_b32 v120, 0xffff, v36
  v_lshlrev_b32 v39, 8, v38
  s_nop 0
  v_add_u32_dpp v76, v120, v55 quad_perm:[0,0,0,0] row_mask:0xf bank_mask:0xf
  v_add_u32_dpp v77, v121, v55 quad_perm:[0,0,0,0] row_mask:0xf bank_mask:0xf
  ds_read_b64_tr_b16 v[84:85], v76 offset:0
  ds_read_b64_tr_b16 v[86:87], v77 offset:0
  ds_read_b64_tr_b16 v[88:89], v76 offset:40960
  ds_read_b64_tr_b16 v[90:91], v77 offset:40960
  v_add_u32_dpp v78, v120, v55 quad_perm:[1,1,1,1] row_mask:0xf bank_mask:0xf
  v_add_u32_dpp v79, v121, v55 quad_perm:[1,1,1,1] row_mask:0xf bank_mask:0xf
  ds_read_b64_tr_b16 v[92:93], v78 offset:0
  ds_read_b64_tr_b16 v[94:95], v79 offset:0
  ds_read_b64_tr_b16 v[96:97], v78 offset:40960
  ds_read_b64_tr_b16 v[98:99], v79 offset:40960
  v_add_u32_dpp v80, v120, v55 quad_perm:[2,2,2,2] row_mask:0xf bank_mask:0xf
  ds_read_b64_tr_b16 v[100:101], v80 offset:0
  ds_read_b64_tr_b16 v[104:105], v80 offset:40960
  v_lshlrev_b64 v[118:119], 1, v[38:39]
  v_pk_ashrrev_i16 v120, 15, v38 op_sel_hi:[0,1]
  v_pk_ashrrev_i16 v121, 15, v39 op_sel_hi:[0,1]
  v_pk_ashrrev_i16 v122, 15, v118 op_sel_hi:[0,1]
  v_pk_ashrrev_i16 v123, 15, v119 op_sel_hi:[0,1]
  v_and_b32_dpp v76, v37, v120 row_newbcast:0 row_mask:0xf bank_mask:0xf
  v_and_b32_dpp v77, v37, v121 row_newbcast:1 row_mask:0xf bank_mask:0xf
  v_and_b32_dpp v78, v37, v122 row_newbcast:2 row_mask:0xf bank_mask:0xf
  v_and_b32_dpp v79, v37, v123 row_newbcast:3 row_mask:0xf bank_mask:0xf
  v_lshlrev_b64 v[116:117], 2, v[38:39]
  v_lshlrev_b64 v[118:119], 3, v[38:39]
  v_pk_ashrrev_i16 v120, 15, v116 op_sel_hi:[0,1]
  v_pk_ashrrev_i16 v121, 15, v117 op_sel_hi:[0,1]
  v_pk_ashrrev_i16 v122, 15, v118 op_sel_hi:[0,1]
  s_waitcnt lgkmcnt(8)
  v_mfma_f32_16x16x32_bf16 v[20:23], v[84:87], v[76:79], v[20:23]
  v_pk_ashrrev_i16 v123, 15, v119 op_sel_hi:[0,1]
  v_and_b32_dpp v80, v37, v120 row_newbcast:4 row_mask:0xf bank_mask:0xf
  v_and_b32_dpp v81, v37, v121 row_newbcast:5 row_mask:0xf bank_mask:0xf
  v_and_b32_dpp v82, v37, v122 row_newbcast:6 row_mask:0xf bank_mask:0xf
  v_and_b32_dpp v83, v37, v123 row_newbcast:7 row_mask:0xf bank_mask:0xf
  s_waitcnt lgkmcnt(6)
  v_mfma_f32_16x16x32_bf16 v[24:27], v[88:91], v[76:79], v[24:27]
  v_lshlrev_b64 v[116:117], 4, v[38:39]
  v_pk_ashrrev_i16 v120, 15, v116 op_sel_hi:[0,1]
  v_pk_ashrrev_i16 v121, 15, v117 op_sel_hi:[0,1]
  s_waitcnt lgkmcnt(4)
  v_mfma_f32_16x16x32_bf16 v[20:23], v[92:95], v[80:83], v[20:23]
  v_and_b32_dpp v76, v37, v120 row_newbcast:8 row_mask:0xf bank_mask:0xf
  v_and_b32_dpp v77, v37, v121 row_newbcast:9 row_mask:0xf bank_mask:0xf
  s_waitcnt lgkmcnt(2)
  v_mfma_f32_16x16x32_bf16 v[24:27], v[96:99], v[80:83], v[24:27]
  s_waitcnt lgkmcnt(1)
  s_nop 0
  v_mfma_f32_16x16x16_bf16 v[20:23], v[100:101], v[76:77], v[20:23]
  s_waitcnt lgkmcnt(0)
  v_mfma_f32_16x16x16_bf16 v[24:27], v[104:105], v[76:77], v[24:27]
  s_branch L_donec1
L_w6c1:
  v_lshrrev_b32 v121, 16, v36
  v_and_b32 v120, 0xffff, v36
  v_lshlrev_b32 v39, 8, v38
  s_nop 0
  v_add_u32_dpp v76, v120, v55 quad_perm:[0,0,0,0] row_mask:0xf bank_mask:0xf
  v_add_u32_dpp v77, v121, v55 quad_perm:[0,0,0,0] row_mask:0xf bank_mask:0xf
  ds_read_b64_tr_b16 v[84:85], v76 offset:0
  ds_read_b64_tr_b16 v[86:87], v77 offset:0
  ds_read_b64_tr_b16 v[88:89], v76 offset:40960
  ds_read_b64_tr_b16 v[90:91], v77 offset:40960
  v_add_u32_dpp v78, v120, v55 quad_perm:[1,1,1,1] row_mask:0xf bank_mask:0xf
  v_add_u32_dpp v79, v121, v55 quad_perm:[1,1,1,1] row_mask:0xf bank_mask:0xf
  ds_read_b64_tr_b16 v[92:93], v78 offset:0
  ds_read_b64_tr_b16 v[94:95], v79 offset:0
  ds_read_b64_tr_b16 v[96:97], v78 offset:40960
  ds_read_b64_tr_b16 v[98:99], v79 offset:40960
  v_add_u32_dpp v80, v120, v55 quad_perm:[2,2,2,2] row_mask:0xf bank_mask:0xf
  v_add_u32_dpp v81, v121, v55 quad_perm:[2,2,2,2] row_mask:0xf bank_mask:0xf
  ds_read_b64_tr_b16 v[100:101], v80 offset:0
  ds_read_b64_tr_b16 v[102:103], v81 offset:0
  ds_read_b64_tr_b16 v[104:105], v80 offset:40960
  ds_read_b64_tr_b16 v[106:107], v81 offset:40960
  v_lshlrev_b64 v[118:119], 1, v[38:39]
  v_pk_ashrrev_i16 v120, 15, v38 op_sel_hi:[0,1]
  v_pk_ashrrev_i16 v121, 15, v39 op_sel_hi:[0,1]
  v_pk_ashrrev_i16 v122, 15, v118 op_sel_hi:[0,1]
  v_pk_ashrrev_i16 v123, 15, v119 op_sel_hi:[0,1]
  v_and_b32_dpp v76, v37, v120 row_newbcast:0 row_mask:0xf bank_mask:0xf
  v_and_b32_dpp v77, v37, v121 row_newbcast:1 row_mask:0xf bank_mask:0xf
  v_and_b32_dpp v78, v37, v122 row_newbcast:2 row_mask:0xf bank_mask:0xf
  v_and_b32_dpp v79, v37, v123 row_newbcast:3 row_mask:0xf bank_mask:0xf
  v_lshlrev_b64 v[116:117], 2, v[38:39]
  v_lshlrev_b64 v[118:119], 3, v[38:39]
  v_pk_ashrrev_i16 v120, 15, v116 op_sel_hi:[0,1]
  v_pk_ashrrev_i16 v121, 15, v117 op_sel_hi:[0,1]
  v_pk_ashrrev_i16 v122, 15, v118 op_sel_hi:[0,1]
  s_waitcnt lgkmcnt(10)
  v_mfma_f32_16x16x32_bf16 v[20:23], v[84:87], v[76:79], v[20:23]
  v_pk_ashrrev_i16 v123, 15, v119 op_sel_hi:[0,1]
  v_and_b32_dpp v80, v37, v120 row_newbcast:4 row_mask:0xf bank_mask:0xf
  v_and_b32_dpp v81, v37, v121 row_newbcast:5 row_mask:0xf bank_mask:0xf
  v_and_b32_dpp v82, v37, v122 row_newbcast:6 row_mask:0xf bank_mask:0xf
  v_and_b32_dpp v83, v37, v123 row_newbcast:7 row_mask:0xf bank_mask:0xf
  s_waitcnt lgkmcnt(8)
  v_mfma_f32_16x16x32_bf16 v[24:27], v[88:91], v[76:79], v[24:27]
  v_lshlrev_b64 v[116:117], 4, v[38:39]
  v_lshlrev_b64 v[118:119], 5, v[38:39]
  v_pk_ashrrev_i16 v120, 15, v116 op_sel_hi:[0,1]
  v_pk_ashrrev_i16 v121, 15, v117 op_sel_hi:[0,1]
  v_pk_ashrrev_i16 v122, 15, v118 op_sel_hi:[0,1]
  s_waitcnt lgkmcnt(6)
  v_mfma_f32_16x16x32_bf16 v[20:23], v[92:95], v[80:83], v[20:23]
  v_pk_ashrrev_i16 v123, 15, v119 op_sel_hi:[0,1]
  v_and_b32_dpp v76, v37, v120 row_newbcast:8 row_mask:0xf bank_mask:0xf
  v_and_b32_dpp v77, v37, v121 row_newbcast:9 row_mask:0xf bank_mask:0xf
  v_and_b32_dpp v78, v37, v122 row_newbcast:10 row_mask:0xf bank_mask:0xf
  v_and_b32_dpp v79, v37, v123 row_newbcast:11 row_mask:0xf bank_mask:0xf
  s_waitcnt lgkmcnt(4)
  v_mfma_f32_16x16x32_bf16 v[24:27], v[96:99], v[80:83], v[24:27]
  s_waitcnt lgkmcnt(2)
  s_nop 0
  v_mfma_f32_16x16x32_bf16 v[20:23], v[100:103], v[76:79], v[20:23]
  s_waitcnt lgkmcnt(0)
  v_mfma_f32_16x16x32_bf16 v[24:27], v[104:107], v[76:79], v[24:27]
  s_branch L_donec1
L_w7c1:
  v_lshrrev_b32 v121, 16, v36
  v_and_b32 v120, 0xffff, v36
  v_lshlrev_b32 v39, 8, v38
  s_nop 0
  v_add_u32_dpp v76, v120, v55 quad_perm:[0,0,0,0] row_mask:0xf bank_mask:0xf
  v_add_u32_dpp v77, v121, v55 quad_perm:[0,0,0,0] row_mask:0xf bank_mask:0xf
  ds_read_b64_tr_b16 v[84:85], v76 offset:0
  ds_read_b64_tr_b16 v[86:87], v77 offset:0
  ds_read_b64_tr_b16 v[88:89], v76 offset:40960
  ds_read_b64_tr_b16 v[90:91], v77 offset:40960
  v_add_u32_dpp v78, v120, v55 quad_perm:[1,1,1,1] row_mask:0xf bank_mask:0xf
  v_add_u32_dpp v79, v121, v55 quad_perm:[1,1,1,1] row_mask:0xf bank_mask:0xf
  ds_read_b64_tr_b16 v[92:93], v78 offset:0
  ds_read_b64_tr_b16 v[94:95], v79 offset:0
  ds_read_b64_tr_b16 v[96:97], v78 offset:40960
  ds_read_b64_tr_b16 v[98:99], v79 offset:40960
  v_add_u32_dpp v80, v120, v55 quad_perm:[2,2,2,2] row_mask:0xf bank_mask:0xf
  v_add_u32_dpp v81, v121, v55 quad_perm:[2,2,2,2] row_mask:0xf bank_mask:0xf
  ds_read_b64_tr_b16 v[100:101], v80 offset:0
  ds_read_b64_tr_b16 v[102:103], v81 offset:0
  ds_read_b64_tr_b16 v[104:105], v80 offset:40960
  ds_read_b64_tr_b16 v[106:107], v81 offset:40960
  v_add_u32_dpp v82, v120, v55 quad_perm:[3,3,3,3] row_mask:0xf bank_mask:0xf
  ds_read_b64_tr_b16 v[108:109], v82 offset:0
  ds_read_b64_tr_b16 v[112:113], v82 offset:40960
  v_lshlrev_b64 v[118:119], 1, v[38:39]
  v_pk_ashrrev_i16 v120, 15, v38 op_sel_hi:[0,1]
  v_pk_ashrrev_i16 v121, 15, v39 op_sel_hi:[0,1]
  v_pk_ashrrev_i16 v122, 15, v118 op_sel_hi:[0,1]
  v_pk_ashrrev_i16 v123, 15, v119 op_sel_hi:[0,1]
  v_and_b32_dpp v76, v37, v120 row_newbcast:0 row_mask:0xf bank_mask:0xf
  v_and_b32_dpp v77, v37, v121 row_newbcast:1 row_mask:0xf bank_mask:0xf
  v_and_b32_dpp v78, v37, v122 row_newbcast:2 row_mask:0xf bank_mask:0xf
  v_and_b32_dpp v79, v37, v123 row_newbcast:3 row_mask:0xf bank_mask:0xf
  v_lshlrev_b64 v[116:117], 2, v[38:39]
  v_lshlrev_b64 v[118:119], 3, v[38:39]
  v_pk_ashrrev_i16 v120, 15, v116 op_sel_hi:[0,1]
  v_pk_ashrrev_i16 v121, 15, v117 op_sel_hi:[0,1]
  v_pk_ashrrev_i16 v122, 15, v118 op_sel_hi:[0,1]
  s_waitcnt lgkmcnt(12)
  v_mfma_f32_16x16x32_bf16 v[20:23], v[84:87], v[76:79], v[20:23]
  v_pk_ashrrev_i16 v123, 15, v119 op_sel_hi:[0,1]
  v_and_b32_dpp v80, v37, v120 row_newbcast:4 row_mask:0xf bank_mask:0xf
  v_and_b32_dpp v81, v37, v121 row_newbcast:5 row_mask:0xf bank_mask:0xf
  v_and_b32_dpp v82, v37, v122 row_newbcast:6 row_mask:0xf bank_mask:0xf
  v_and_b32_dpp v83, v37, v123 row_newbcast:7 row_mask:0xf bank_mask:0xf
  s_waitcnt lgkmcnt(10)
  v_mfma_f32_16x16x32_bf16 v[24:27], v[88:91], v[76:79], v[24:27]
  v_lshlrev_b64 v[116:117], 4, v[38:39]
  v_lshlrev_b64 v[118:119], 5, v[38:39]
  v_pk_ashrrev_i16 v120, 15, v116 op_sel_hi:[0,1]
  v_pk_ashrrev_i16 v121, 15, v117 op_sel_hi:[0,1]
  v_pk_ashrrev_i16 v122, 15, v118 op_sel_hi:[0,1]
  s_waitcnt lgkmcnt(8)
  v_mfma_f32_16x16x32_bf16 v[20:23], v[92:95], v[80:83], v[20:23]
  v_pk_ashrrev_i16 v123, 15, v119 op_sel_hi:[0,1]
  v_and_b32_dpp v76, v37, v120 row_newbcast:8 row_mask:0xf bank_mask:0xf
  v_and_b32_dpp v77, v37, v121 row_newbcast:9 row_mask:0xf bank_mask:0xf
  v_and_b32_dpp v78, v37, v122 row_newbcast:10 row_mask:0xf bank_mask:0xf
  v_and_b32_dpp v79, v37, v123 row_newbcast:11 row_mask:0xf bank_mask:0xf
  s_waitcnt lgkmcnt(6)
  v_mfma_f32_16x16x32_bf16 v[24:27], v[96:99], v[80:83], v[24:27]
  v_lshlrev_b64 v[116:117], 6, v[38:39]
  v_pk_ashrrev_i16 v120, 15, v116 op_sel_hi:[0,1]
  v_pk_ashrrev_i16 v121, 15, v117 op_sel_hi:[0,1]
  s_waitcnt lgkmcnt(4)
  v_mfma_f32_16x16x32_bf16 v[20:23], v[100:103], v[76:79], v[20:23]
  v_and_b32_dpp v80, v37, v120 row_newbcast:12 row_mask:0xf bank_mask:0xf
  v_and_b32_dpp v81, v37, v121 row_newbcast:13 row_mask:0xf bank_mask:0xf
  s_waitcnt lgkmcnt(2)
  v_mfma_f32_16x16x32_bf16 v[24:27], v[104:107], v[76:79], v[24:27]
  s_waitcnt lgkmcnt(1)
  s_nop 0
  v_mfma_f32_16x16x16_bf16 v[20:23], v[108:109], v[80:81], v[20:23]
  s_waitcnt lgkmcnt(0)
  v_mfma_f32_16x16x16_bf16 v[24:27], v[112:113], v[80:81], v[24:27]
  s_branch L_donec1
L_slowc1:
  s_mul_i32 s25, s24, 10223616
  s_add_u32 s25, s25, s17
  s_add_u32 s25, s25, 239616
  buffer_load_dwordx3 v[36:38], v59, s[4:7], s25 offen
  s_waitcnt vmcnt(0)
  s_branch L_blkc1
L_morec1:
  s_add_u32 s24, s24, 1
  s_cmp_lg_u32 s24, 1
  s_cbranch_scc1 L_slowc1
  v_mov_b32 v36, v60
  v_mov_b32 v37, v61
  v_mov_b32 v38, v62
  s_branch L_blkc1
L_v4c1:
  v_lshrrev_b32 v121, 16, v36
  v_and_b32 v120, 0xffff, v36
  v_lshlrev_b32 v39, 8, v38
  s_nop 0
  v_add_u32_dpp v76, v120, v55 quad_perm:[0,0,0,0] row_mask:0xf bank_mask:0xf
  v_add_u32_dpp v77, v121, v55 quad_perm:[0,0,0,0] row_mask:0xf bank_mask:0xf
  ds_read_b64_tr_b16 v[84:85], v76 offset:0
  ds_read_b64_tr_b16 v[86:87], v77 offset:0
  ds_read_b64_tr_b16 v[88:89], v76 offset:40960
  ds_read_b64_tr_b16 v[90:91], v77 offset:40960
  v_add_u32_dpp v78, v120, v55 quad_perm:[1,1,1,1] row_mask:0xf bank_mask:0xf
  v_add_u32_dpp v79, v121, v55 quad_perm:[1,1,1,1] row_mask:0xf bank_mask:0xf
  ds_read_b64_tr_b16 v[92:93], v78 offset:0
  ds_read_b64_tr_b16 v[94:95], v79 offset:0
  ds_read_b64_tr_b16 v[96:97], v78 offset:40960
  ds_read_b64_tr_b16 v[98:99], v79 offset:40960
  v_add_u32_dpp v80, v120, v55 quad_perm:[2,2,2,2] row_mask:0xf bank_mask:0xf
  v_add_u32_dpp v81, v121, v55 quad_perm:[2,2,2,2] row_mask:0xf bank_mask:0xf
  ds_read_b64_tr_b16 v[100:101], v80 offset:0
  ds_read_b64_tr_b16 v[102:103], v81 offset:0
  ds_read_b64_tr_b16 v[104:105], v80 offset:40960
  ds_read_b64_tr_b16 v[106:107], v81 offset:40960
  v_add_u32_dpp v82, v120, v55 quad_perm:[3,3,3,3] row_mask:0xf bank_mask:0xf
  v_add_u32_dpp v83, v121, v55 quad_perm:[3,3,3,3] row_mask:0xf bank_mask:0xf
  ds_read_b64_tr_b16 v[108:109], v82 offset:0
  ds_read_b64_tr_b16 v[110:111], v83 offset:0
  ds_read_b64_tr_b16 v[112:113], v82 offset:40960
  ds_read_b64_tr_b16 v[114:115], v83 offset:40960
  v_lshlrev_b64 v[118:119], 1, v[38:39]
  v_pk_ashrrev_i16 v120, 15, v38 op_sel_hi:[0,1]
  v_pk_ashrrev_i16 v121, 15, v39 op_sel_hi:[0,1]
  v_pk_ashrrev_i16 v122, 15, v118 op_sel_hi:[0,1]
  v_pk_ashrrev_i16 v123, 15, v119 op_sel_hi:[0,1]
  v_and_b32_dpp v76, v37, v120 row_newbcast:0 row_mask:0xf bank_mask:0xf
  v_and_b32_dpp v77, v37, v121 row_newbcast:1 row_mask:0xf bank_mask:0xf
  v_and_b32_dpp v78, v37, v122 row_newbcast:2 row_mask:0xf bank_mask:0xf
  v_and_b32_dpp v79, v37, v123 row_newbcast:3 row_mask:0xf bank_mask:0xf
  v_lshlrev_b64 v[116:117], 2, v[38:39]
  v_lshlrev_b64 v[118:119], 3, v[38:39]
  v_pk_ashrrev_i16 v120, 15, v116 op_sel_hi:[0,1]
  v_pk_ashrrev_i16 v121, 15, v117 op_sel_hi:[0,1]
  v_pk_ashrrev_i16 v122, 15, v118 op_sel_hi:[0,1]
  s_waitcnt lgkmcnt(14)
  v_mfma_f32_16x16x32_bf16 v[20:23], v[84:87], v[76:79], v[20:23]
  v_pk_ashrrev_i16 v123, 15, v119 op_sel_hi:[0,1]
  v_and_b32_dpp v80, v37, v120 row_newbcast:4 row_mask:0xf bank_mask:0xf
  v_and_b32_dpp v81, v37, v121 row_newbcast:5 row_mask:0xf bank_mask:0xf
  v_and_b32_dpp v82, v37, v122 row_newbcast:6 row_mask:0xf bank_mask:0xf
  v_and_b32_dpp v83, v37, v123 row_newbcast:7 row_mask:0xf bank_mask:0xf
  s_waitcnt lgkmcnt(12)
  v_mfma_f32_16x16x32_bf16 v[24:27], v[88:91], v[76:79], v[24:27]
  v_lshlrev_b64 v[116:117], 4, v[38:39]
  v_lshlrev_b64 v[118:119], 5, v[38:39]
  v_pk_ashrrev_i16 v120, 15, v116 op_sel_hi:[0,1]
  v_pk_ashrrev_i16 v121, 15, v117 op_sel_hi:[0,1]
  v_pk_ashrrev_i16 v122, 15, v118 op_sel_hi:[0,1]
  s_waitcnt lgkmcnt(10)
  v_mfma_f32_16x16x32_bf16 v[20:23], v[92:95], v[80:83], v[20:23]
  v_pk_ashrrev_i16 v123, 15, v119 op_sel_hi:[0,1]
  v_and_b32_dpp v76, v37, v120 row_newbcast:8 row_mask:0xf bank_mask:0xf
  v_and_b32_dpp v77, v37, v121 row_newbcast:9 row_mask:0xf bank_mask:0xf
  v_and_b32_dpp v78, v37, v122 row_newbcast:10 row_mask:0xf bank_mask:0xf
  v_and_b32_dpp v79, v37, v123 row_newbcast:11 row_mask:0xf bank_mask:0xf
  s_waitcnt lgkmcnt(8)
  v_mfma_f32_16x16x32_bf16 v[24:27], v[96:99], v[80:83], v[24:27]
  v_lshlrev_b64 v[116:117], 6, v[38:39]
  v_lshlrev_b64 v[118:119], 7, v[38:39]
  v_pk_ashrrev_i16 v120, 15, v116 op_sel_hi:[0,1]
  v_pk_ashrrev_i16 v121, 15, v117 op_sel_hi:[0,1]
  v_pk_ashrrev_i16 v122, 15, v118 op_sel_hi:[0,1]
  s_waitcnt lgkmcnt(6)
  v_mfma_f32_16x16x32_bf16 v[20:23], v[100:103], v[76:79], v[20:23]
  v_pk_ashrrev_i16 v123, 15, v119 op_sel_hi:[0,1]
  v_and_b32_dpp v80, v37, v120 row_newbcast:12 row_mask:0xf bank_mask:0xf
  v_and_b32_dpp v81, v37, v121 row_newbcast:13 row_mask:0xf bank_mask:0xf
  v_and_b32_dpp v82, v37, v122 row_newbcast:14 row_mask:0xf bank_mask:0xf
  v_and_b32_dpp v83, v37, v123 row_newbcast:15 row_mask:0xf bank_mask:0xf
  s_waitcnt lgkmcnt(4)
  v_mfma_f32_16x16x32_bf16 v[24:27], v[104:107], v[76:79], v[24:27]
  s_waitcnt lgkmcnt(2)
  s_nop 0
  v_mfma_f32_16x16x32_bf16 v[20:23], v[108:111], v[80:83], v[20:23]
  s_waitcnt lgkmcnt(0)
  v_mfma_f32_16x16x32_bf16 v[24:27], v[112:115], v[80:83], v[24:27]
  s_sub_u32 s22, s22, 8
  s_cmp_lg_u32 s22, 0
  s_cbranch_scc1 L_morec1
L_donec1:
  s_cmp_ge_u32 s29, 8
  s_cbranch_scc1 L_nfc1
  s_add_u32 s26, s16, 34
  s_add_u32 s25, s17, 241152
  v_readlane_b32 s22, v63, s26
  buffer_load_dwordx3 v[36:38], v59, s[4:7], s25 offen
  s_cmp_le_u32 s22, 8
  s_cbranch_scc1 L_nfc1
  s_add_u32 s25, s25, 10223616
  buffer_load_dwordx3 v[60:62], v59, s[4:7], s25 offen
L_nfc1:
  s_setprio 2
  s_mov_b32 s24, 0
L_blka1:
  s_cmp_ge_u32 s20, 8
  s_cbranch_scc1 L_v4a1
  s_cmp_eq_u32 s20, 7
  s_cbranch_scc1 L_w7a1
  s_cmp_eq_u32 s20, 6
  s_cbranch_scc1 L_w6a1
  s_cmp_eq_u32 s20, 5
  s_cbranch_scc1 L_w5a1
  s_cmp_eq_u32 s20, 4
  s_cbranch_scc1 L_w4a1
  s_cmp_eq_u32 s20, 3
  s_cbranch_scc1 L_w3a1
  s_cmp_eq_u32 s20, 2
  s_cbranch_scc1 L_w2a1
  s_cmp_eq_u32 s20, 0
  s_cbranch_scc1 L_donea1
L_w1a1:
  v_and_b32 v120, 0xffff, v28
  v_lshlrev_b32 v31, 8, v30
  s_nop 0
  v_add_u32_dpp v76, v120, v55 quad_perm:[0,0,0,0] row_mask:0xf bank_mask:0xf
  ds_read_b64_tr_b16 v[84:85], v76 offset:0
  ds_read_b64_tr_b16 v[88:89], v76 offset:40960
  v_pk_ashrrev_i16 v120, 15, v30 op_sel_hi:[0,1]
  v_pk_ashrrev_i16 v121, 15, v31 op_sel_hi:[0,1]
  v_and_b32_dpp v76, v29, v120 row_newbcast:0 row_mask:0xf bank_mask:0xf
  v_and_b32_dpp v77, v29, v121 row_newbcast:1 row_mask:0xf bank_mask:0xf
  s_waitcnt lgkmcnt(1)
  s_nop 0
  v_mfma_f32_16x16x16_bf16 v[4:7], v[84:85], v[76:77], v[4:7]
  s_waitcnt lgkmcnt(0)
  v_mfma_f32_16x16x16_bf16 v[8:11], v[88:89], v[76:77], v[8:11]
  s_branch L_donea1
L_w2a1:
  v_lshrrev_b32 v121, 16, v28
  v_and_b32 v120, 0xffff, v28
  v_lshlrev_b32 v31, 8, v30
  s_nop 0
  v_add_u32_dpp v76, v120, v55 quad_perm:[0,0,0,0] row_mask:0xf bank_mask:0xf
  v_add_u32_dpp v77, v121, v55 quad_perm:[0,0,0,0] row_mask:0xf bank_mask:0xf
  ds_read_b64_tr_b16 v[84:85], v76 offset:0
  ds_read_b64_tr_b16 v[86:87], v77 offset:0
  ds_read_b64_tr_b16 v[88:89], v76 offset:40960
  ds_read_b64_tr_b16 v[90:91], v77 offset:40960
  v_lshlrev_b64 v[118:119], 1, v[30:31]
  v_pk_ashrrev_i16 v120, 15, v30 op_sel_hi:[0,1]
  v_pk_ashrrev_i16 v121, 15, v31 op_sel_hi:[0,1]
  v_pk_ashrrev_i16 v122, 15, v118 op_sel_hi:[0,1]
  v_pk_ashrrev_i16 v123, 15, v119 op_sel_hi:[0,1]
  v_and_b32_dpp v76, v29, v120 row_newbcast:0 row_mask:0xf bank_mask:0xf
  v_and_b32_dpp v77, v29, v121 row_newbcast:1 row_mask:0xf bank_mask:0xf
  v_and_b32_dpp v78, v29, v122 row_newbcast:2 row_mask:0xf bank_mask:0xf
  v_and_b32_dpp v79, v29, v123 row_newbcast:3 row_mask:0xf bank_mask:0xf
  s_waitcnt lgkmcnt(2)
  s_nop 0
  v_mfma_f32_16x16x32_bf16 v[4:7], v[84:87], v[76:79], v[4:7]
  s_waitcnt lgkmcnt(0)
  v_mfma_f32_16x16x32_bf16 v[8:11], v[88:91], v[76:79], v[8:11]
  s_branch L_donea1
L_w3a1:
  v_lshrrev_b32 v121, 16, v28
  v_and_b32 v120, 0xffff, v28
  v_lshlrev_b32 v31, 8, v30
  s_nop 0
  v_add_u32_dpp v76, v120, v55 quad_perm:[0,0,0,0] row_mask:0xf bank_mask:0xf
  v_add_u32_dpp v77, v121, v55 quad_perm:[0,0,0,0] row_mask:0xf bank_mask:0xf
  ds_read_b64_tr_b16 v[84:85], v76 offset:0
  ds_read_b64_tr_b16 v[86:87], v77 offset:0
  ds_read_b64_tr_b16 v[88:89], v76 offset:40960
  ds_read_b64_tr_b16 v[90:91], v77 offset:40960
  v_add_u32_dpp v78, v120, v55 quad_perm:[1,1,1,1] row_mask:0xf bank_mask:0xf
  ds_read_b64_tr_b16 v[92:93], v78 offset:0
  ds_read_b64_tr_b16 v[96:97], v78 offset:40960
  v_lshlrev_b64 v[118:119], 1, v[30:31]
  v_pk_ashrrev_i16 v120, 15, v30 op_sel_hi:[0,1]
  v_pk_ashrrev_i16 v121, 15, v31 op_sel_hi:[0,1]
  v_pk_ashrrev_i16 v122, 15, v118 op_sel_hi:[0,1]
  v_pk_ashrrev_i16 v123, 15, v119 op_sel_hi:[0,1]
  v_and_b32_dpp v76, v29, v120 row_newbcast:0 row_mask:0xf bank_mask:0xf
  v_and_b32_dpp v77, v29, v121 row_newbcast:1 row_mask:0xf bank_mask:0xf
  v_and_b32_dpp v78, v29, v122 row_newbcast:2 row_mask:0xf bank_mask:0xf
  v_and_b32_dpp v79, v29, v123 row_newbcast:3 row_mask:0xf bank_mask:0xf
  v_lshlrev_b64 v[116:117], 2, v[30:31]
  v_pk_ashrrev_i16 v120, 15, v116 op_sel_hi:[0,1]
  v_pk_ashrrev_i16 v121, 15, v117 op_sel_hi:[0,1]
  s_waitcnt lgkmcnt(4)
  v_mfma_f32_16x16x32_bf16 v[4:7], v[84:87], v[76:79], v[4:7]
  v_and_b32_dpp v80, v29, v120 row_newbcast:4 row_mask:0xf bank_mask:0xf
  v_and_b32_dpp v81, v29, v121 row_newbcast:5 row_mask:0xf bank_mask:0xf
  s_waitcnt lgkmcnt(2)
  v_mfma_f32_16x16x32_bf16 v[8:11], v[88:91], v[76:79], v[8:11]
  s_waitcnt lgkmcnt(1)
  s_nop 0
  v_mfma_f32_16x16x16_bf16 v[4:7], v[92:93], v[80:81], v[4:7]
  s_waitcnt lgkmcnt(0)
  v_mfma_f32_16x16x16_bf16 v[8:11], v[96:97], v[80:81], v[8:11]
  s_branch L_donea1
L_w4a1:
  v_lshrrev_b32 v121, 16, v28
  v_and_b32 v120, 0xffff, v28
  v_lshlrev_b32 v31, 8, v30
  s_nop 0
  v_add_u32_dpp v76, v120, v55 quad_perm:[0,0,0,0] row_mask:0xf bank_mask:0xf
  v_add_u32_dpp v77, v121, v55 quad_perm:[0,0,0,0] row_mask:0xf bank_mask:0xf
  ds_read_b64_tr_b16 v[84:85], v76 offset:0
  ds_read_b64_tr_b16 v[86:87], v77 offset:0
  ds_read_b64_tr_b16 v[88:89], v76 offset:40960
  ds_read_b64_tr_b16 v[90:91], v77 offset:40960
  v_add_u32_dpp v78, v120, v55 quad_perm:[1,1,1,1] row_mask:0xf bank_mask:0xf
  v_add_u32_dpp v79, v121, v55 quad_perm:[1,1,1,1] row_mask:0xf bank_mask:0xf
  ds_read_b64_tr_b16 v[92:93], v78 offset:0
  ds_read_b64_tr_b16 v[94:95], v79 offset:0
  ds_read_b64_tr_b16 v[96:97], v78 offset:40960
  ds_read_b64_tr_b16 v[98:99], v79 offset:40960
  v_lshlrev_b64 v[118:119], 1, v[30:31]
  v_pk_ashrrev_i16 v120, 15, v30 op_sel_hi:[0,1]
  v_pk_ashrrev_i16 v121, 15, v31 op_sel_hi:[0,1]
  v_pk_ashrrev_i16 v122, 15, v118 op_sel_hi:[0,1]
  v_pk_ashrrev_i16 v123, 15, v119 op_sel_hi:[0,1]
  v_and_b32_dpp v76, v29, v120 row_newbcast:0 row_mask:0xf bank_mask:0xf
  v_and_b32_dpp v77, v29, v121 row_newbcast:1 row_mask:0xf bank_mask:0xf
  v_and_b32_dpp v78, v29, v122 row_newbcast:2 row_mask:0xf bank_mask:0xf
  v_and_b32_dpp v79, v29, v123 row_newbcast:3 row_mask:0xf bank_mask:0xf
  v_lshlrev_b64 v[116:117], 2, v[30:31]
  v_lshlrev_b64 v[118:119], 3, v[30:31]
  v_pk_ashrrev_i16 v120, 15, v116 op_sel_hi:[0,1]
  v_pk_ashrrev_i16 v121, 15, v117 op_sel_hi:[0,1]
  v_pk_ashrrev_i16 v122, 15, v118 op_sel_hi:[0,1]
  s_waitcnt lgkmcnt(6)
  v_mfma_f32_16x16x32_bf16 v[4:7], v[84:87], v[76:79], v[4:7]
  v_pk_ashrrev_i16 v123, 15, v119 op_sel_hi:[0,1]
  v_and_b32_dpp v80, v29, v120 row_newbcast:4 row_mask:0xf bank_mask:0xf
  v_and_b32_dpp v81, v29, v121 row_newbcast:5 row_mask:0xf bank_mask:0xf
  v_and_b32_dpp v82, v29, v122 row_newbcast:6 row_mask:0xf bank_mask:0xf
  v_and_b32_dpp v83, v29, v123 row_newbcast:7 row_mask:0xf bank_mask:0xf
  s_waitcnt lgkmcnt(4)
  v_mfma_f32_16x16x32_bf16 v[8:11], v[88:91], v[76:79], v[8:11]
  s_waitcnt lgkmcnt(2)
  s_nop 0
  v_mfma_f32_16x16x32_bf16 v[4:7], v[92:95], v[80:83], v[4:7]
  s_waitcnt lgkmcnt(0)
  v_mfma_f32_16x16x32_bf16 v[8:11], v[96:99], v[80:83], v[8:11]
  s_branch L_donea1
L_w5a1:
  v_lshrrev_b32 v121, 16, v28
  v_and_b32 v120, 0xffff, v28
  v_lshlrev_b32 v31, 8, v30
  s_nop 0
  v_add_u32_dpp v76, v120, v55 quad_perm:[0,0,0,0] row_mask:0xf bank_mask:0xf
  v_add_u32_dpp v77, v121, v55 quad_perm:[0,0,0,0] row_mask:0xf bank_mask:0xf
  ds_read_b64_tr_b16 v[84:85], v76 offset:0
  ds_read_b64_tr_b16 v[86:87], v77 offset:0
  ds_read_b64_tr_b16 v[88:89], v76 offset:40960
  ds_read_b64_tr_b16 v[90:91], v77 offset:40960
  v_add_u32_dpp v78, v120, v55 quad_perm:[1,1,1,1] row_mask:0xf bank_mask:0xf
  v_add_u32_dpp v79, v121, v55 quad_perm:[1,1,1,1] row_mask:0xf bank_mask:0xf
  ds_read_b64_tr_b16 v[92:93], v78 offset:0
  ds_read_b64_tr_b16 v[94:95], v79 offset:0
  ds_read_b64_tr_b16 v[96:97], v78 offset:40960
  ds_read_b64_tr_b16 v[98:99], v79 offset:40960
  v_add_u32_dpp v80, v120, v55 quad_perm:[2,2,2,2] row_mask:0xf bank_mask:0xf
  ds_read_b64_tr_b16 v[100:101], v80 offset:0
  ds_read_b64_tr_b16 v[104:105], v80 offset:40960
  v_lshlrev_b64 v[118:119], 1, v[30:31]
  v_pk_ashrrev_i16 v120, 15, v30 op_sel_hi:[0,1]
  v_pk_ashrrev_i16 v121, 15, v31 op_sel_hi:[0,1]
  v_pk_ashrrev_i16 v122, 15, v118 op_sel_hi:[0,1]
  v_pk_ashrrev_i16 v123, 15, v119 op_sel_hi:[0,1]
  v_and_b32_dpp v76, v29, v120 row_newbcast:0 row_mask:0xf bank_mask:0xf
  v_and_b32_dpp v77, v29, v121 row_newbcast:1 row_mask:0xf bank_mask:0xf
  v_and_b32_dpp v78, v29, v122 row_newbcast:2 row_mask:0xf bank_mask:0xf
  v_and_b32_dpp v79, v29, v123 row_newbcast:3 row_mask:0xf bank_mask:0xf
  v_lshlrev_b64 v[116:117], 2, v[30:31]
  v_lshlrev_b64 v[118:119], 3, v[30:31]
  v_pk_ashrrev_i16 v120, 15, v116 op_sel_hi:[0,1]
  v_pk_ashrrev_i16 v121, 15, v117 op_sel_hi:[0,1]
  v_pk_ashrrev_i16 v122, 15, v118 op_sel_hi:[0,1]
  s_waitcnt lgkmcnt(8)
  v_mfma_f32_16x16x32_bf16 v[4:7], v[84:87], v[76:79], v[4:7]
  v_pk_ashrrev_i16 v123, 15, v119 op_sel_hi:[0,1]
  v_and_b32_dpp v80, v29, v120 row_newbcast:4 row_mask:0xf bank_mask:0xf
  v_and_b32_dpp v81, v29, v121 row_newbcast:5 row_mask:0xf bank_mask:0xf
  v_and_b32_dpp v82, v29, v122 row_newbcast:6 row_mask:0xf bank_mask:0xf
  v_and_b32_dpp v83, v29, v123 row_newbcast:7 row_mask:0xf bank_mask:0xf
  s_waitcnt lgkmcnt(6)
  v_mfma_f32_16x16x32_bf16 v[8:11], v[88:91], v[76:79], v[8:11]
  v_lshlrev_b64 v[116:117], 4, v[30:31]
  v_pk_ashrrev_i16 v120, 15, v116 op_sel_hi:[0,1]
  v_pk_ashrrev_i16 v121, 15, v117 op_sel_hi:[0,1]
  s_waitcnt lgkmcnt(4)
  v_mfma_f32_16x16x32_bf16 v[4:7], v[92:95], v[80:83], v[4:7]
  v_and_b32_dpp v76, v29, v120 row_newbcast:8 row_mask:0xf bank_mask:0xf
  v_and_b32_dpp v77, v29, v121 row_newbcast:9 row_mask:0xf bank_mask:0xf
  s_waitcnt lgkmcnt(2)
  v_mfma_f32_16x16x32_bf16 v[8:11], v[96:99], v[80:83], v[8:11]
  s_waitcnt lgkmcnt(1)
  s_nop 0
  v_mfma_f32_16x16x16_bf16 v[4:7], v[100:101], v[76:77], v[4:7]
  s_waitcnt lgkmcnt(0)
  v_mfma_f32_16x16x16_bf16 v[8:11], v[104:105], v[76:77], v[8:11]
  s_branch L_donea1
L_w6a1:
  v_lshrrev_b32 v121, 16, v28
  v_and_b32 v120, 0xffff, v28
  v_lshlrev_b32 v31, 8, v30
  s_nop 0
  v_add_u32_dpp v76, v120, v55 quad_perm:[0,0,0,0] row_mask:0xf bank_mask:0xf
  v_add_u32_dpp v77, v121, v55 quad_perm:[0,0,0,0] row_mask:0xf bank_mask:0xf
  ds_read_b64_tr_b16 v[84:85], v76 offset:0
  ds_read_b64_tr_b16 v[86:87], v77 offset:0
  ds_read_b64_tr_b16 v[88:89], v76 offset:40960
  ds_read_b64_tr_b16 v[90:91], v77 offset:40960
  v_add_u32_dpp v78, v120, v55 quad_perm:[1,1,1,1] row_mask:0xf bank_mask:0xf
  v_add_u32_dpp v79, v121, v55 quad_perm:[1,1,1,1] row_mask:0xf bank_mask:0xf
  ds_read_b64_tr_b16 v[92:93], v78 offset:0
  ds_read_b64_tr_b16 v[94:95], v79 offset:0
  ds_read_b64_tr_b16 v[96:97], v78 offset:40960
  ds_read_b64_tr_b16 v[98:99], v79 offset:40960
  v_add_u32_dpp v80, v120, v55 quad_perm:[2,2,2,2] row_mask:0xf bank_mask:0xf
  v_add_u32_dpp v81, v121, v55 quad_perm:[2,2,2,2] row_mask:0xf bank_mask:0xf
  ds_read_b64_tr_b16 v[100:101], v80 offset:0
  ds_read_b64_tr_b16 v[102:103], v81 offset:0
  ds_read_b64_tr_b16 v[104:105], v80 offset:40960
  ds_read_b64_tr_b16 v[106:107], v81 offset:40960
  v_lshlrev_b64 v[118:119], 1, v[30:31]
  v_pk_ashrrev_i16 v120, 15, v30 op_sel_hi:[0,1]
  v_pk_ashrrev_i16 v121, 15, v31 op_sel_hi:[0,1]
  v_pk_ashrrev_i16 v122, 15, v118 op_sel_hi:[0,1]
  v_pk_ashrrev_i16 v123, 15, v119 op_sel_hi:[0,1]
  v_and_b32_dpp v76, v29, v120 row_newbcast:0 row_mask:0xf bank_mask:0xf
  v_and_b32_dpp v77, v29, v121 row_newbcast:1 row_mask:0xf bank_mask:0xf
  v_and_b32_dpp v78, v29, v122 row_newbcast:2 row_mask:0xf bank_mask:0xf
  v_and_b32_dpp v79, v29, v123 row_newbcast:3 row_mask:0xf bank_mask:0xf
  v_lshlrev_b64 v[116:117], 2, v[30:31]
  v_lshlrev_b64 v[118:119], 3, v[30:31]
  v_pk_ashrrev_i16 v120, 15, v116 op_sel_hi:[0,1]
  v_pk_ashrrev_i16 v121, 15, v117 op_sel_hi:[0,1]
  v_pk_ashrrev_i16 v122, 15, v118 op_sel_hi:[0,1]
  s_waitcnt lgkmcnt(10)
  v_mfma_f32_16x16x32_bf16 v[4:7], v[84:87], v[76:79], v[4:7]
  v_pk_ashrrev_i16 v123, 15, v119 op_sel_hi:[0,1]
  v_and_b32_dpp v80, v29, v120 row_newbcast:4 row_mask:0xf bank_mask:0xf
  v_and_b32_dpp v81, v29, v121 row_newbcast:5 row_mask:0xf bank_mask:0xf
  v_and_b32_dpp v82, v29, v122 row_newbcast:6 row_mask:0xf bank_mask:0xf
  v_and_b32_dpp v83, v29, v123 row_newbcast:7 row_mask:0xf bank_mask:0xf
  s_waitcnt lgkmcnt(8)
  v_mfma_f32_16x16x32_bf16 v[8:11], v[88:91], v[76:79], v[8:11]
  v_lshlrev_b64 v[116:117], 4, v[30:31]
  v_lshlrev_b64 v[118:119], 5, v[30:31]
  v_pk_ashrrev_i16 v120, 15, v116 op_sel_hi:[0,1]
  v_pk_ashrrev_i16 v121, 15, v117 op_sel_hi:[0,1]
  v_pk_ashrrev_i16 v122, 15, v118 op_sel_hi:[0,1]
  s_waitcnt lgkmcnt(6)
  v_mfma_f32_16x16x32_bf16 v[4:7], v[92:95], v[80:83], v[4:7]
  v_pk_ashrrev_i16 v123, 15, v119 op_sel_hi:[0,1]
  v_and_b32_dpp v76, v29, v120 row_newbcast:8 row_mask:0xf bank_mask:0xf
  v_and_b32_dpp v77, v29, v121 row_newbcast:9 row_mask:0xf bank_mask:0xf
  v_and_b32_dpp v78, v29, v122 row_newbcast:10 row_mask:0xf bank_mask:0xf
  v_and_b32_dpp v79, v29, v123 row_newbcast:11 row_mask:0xf bank_mask:0xf
  s_waitcnt lgkmcnt(4)
  v_mfma_f32_16x16x32_bf16 v[8:11], v[96:99], v[80:83], v[8:11]
  s_waitcnt lgkmcnt(2)
  s_nop 0
  v_mfma_f32_16x16x32_bf16 v[4:7], v[100:103], v[76:79], v[4:7]
  s_waitcnt lgkmcnt(0)
  v_mfma_f32_16x16x32_bf16 v[8:11], v[104:107], v[76:79], v[8:11]
  s_branch L_donea1
L_w7a1:
  v_lshrrev_b32 v121, 16, v28
  v_and_b32 v120, 0xffff, v28
  v_lshlrev_b32 v31, 8, v30
  s_nop 0
  v_add_u32_dpp v76, v120, v55 quad_perm:[0,0,0,0] row_mask:0xf bank_mask:0xf
  v_add_u32_dpp v77, v121, v55 quad_perm:[0,0,0,0] row_mask:0xf bank_mask:0xf
  ds_read_b64_tr_b16 v[84:85], v76 offset:0
  ds_read_b64_tr_b16 v[86:87], v77 offset:0
  ds_read_b64_tr_b16 v[88:89], v76 offset:40960
  ds_read_b64_tr_b16 v[90:91], v77 offset:40960
  v_add_u32_dpp v78, v120, v55 quad_perm:[1,1,1,1] row_mask:0xf bank_mask:0xf
  v_add_u32_dpp v79, v121, v55 quad_perm:[1,1,1,1] row_mask:0xf bank_mask:0xf
  ds_read_b64_tr_b16 v[92:93], v78 offset:0
  ds_read_b64_tr_b16 v[94:95], v79 offset:0
  ds_read_b64_tr_b16 v[96:97], v78 offset:40960
  ds_read_b64_tr_b16 v[98:99], v79 offset:40960
  v_add_u32_dpp v80, v120, v55 quad_perm:[2,2,2,2] row_mask:0xf bank_mask:0xf
  v_add_u32_dpp v81, v121, v55 quad_perm:[2,2,2,2] row_mask:0xf bank_mask:0xf
  ds_read_b64_tr_b16 v[100:101], v80 offset:0
  ds_read_b64_tr_b16 v[102:103], v81 offset:0
  ds_read_b64_tr_b16 v[104:105], v80 offset:40960
  ds_read_b64_tr_b16 v[106:107], v81 offset:40960
  v_add_u32_dpp v82, v120, v55 quad_perm:[3,3,3,3] row_mask:0xf bank_mask:0xf
  ds_read_b64_tr_b16 v[108:109], v82 offset:0
  ds_read_b64_tr_b16 v[112:113], v82 offset:40960
  v_lshlrev_b64 v[118:119], 1, v[30:31]
  v_pk_ashrrev_i16 v120, 15, v30 op_sel_hi:[0,1]
  v_pk_ashrrev_i16 v121, 15, v31 op_sel_hi:[0,1]
  v_pk_ashrrev_i16 v122, 15, v118 op_sel_hi:[0,1]
  v_pk_ashrrev_i16 v123, 15, v119 op_sel_hi:[0,1]
  v_and_b32_dpp v76, v29, v120 row_newbcast:0 row_mask:0xf bank_mask:0xf
  v_and_b32_dpp v77, v29, v121 row_newbcast:1 row_mask:0xf bank_mask:0xf
  v_and_b32_dpp v78, v29, v122 row_newbcast:2 row_mask:0xf bank_mask:0xf
  v_and_b32_dpp v79, v29, v123 row_newbcast:3 row_mask:0xf bank_mask:0xf
  v_lshlrev_b64 v[116:117], 2, v[30:31]
  v_lshlrev_b64 v[118:119], 3, v[30:31]
  v_pk_ashrrev_i16 v120, 15, v116 op_sel_hi:[0,1]
  v_pk_ashrrev_i16 v121, 15, v117 op_sel_hi:[0,1]
  v_pk_ashrrev_i16 v122, 15, v118 op_sel_hi:[0,1]
  s_waitcnt lgkmcnt(12)
  v_mfma_f32_16x16x32_bf16 v[4:7], v[84:87], v[76:79], v[4:7]
  v_pk_ashrrev_i16 v123, 15, v119 op_sel_hi:[0,1]
  v_and_b32_dpp v80, v29, v120 row_newbcast:4 row_mask:0xf bank_mask:0xf
  v_and_b32_dpp v81, v29, v121 row_newbcast:5 row_mask:0xf bank_mask:0xf
  v_and_b32_dpp v82, v29, v122 row_newbcast:6 row_mask:0xf bank_mask:0xf
  v_and_b32_dpp v83, v29, v123 row_newbcast:7 row_mask:0xf bank_mask:0xf
  s_waitcnt lgkmcnt(10)
  v_mfma_f32_16x16x32_bf16 v[8:11], v[88:91], v[76:79], v[8:11]
  v_lshlrev_b64 v[116:117], 4, v[30:31]
  v_lshlrev_b64 v[118:119], 5, v[30:31]
  v_pk_ashrrev_i16 v120, 15, v116 op_sel_hi:[0,1]
  v_pk_ashrrev_i16 v121, 15, v117 op_sel_hi:[0,1]
  v_pk_ashrrev_i16 v122, 15, v118 op_sel_hi:[0,1]
  s_waitcnt lgkmcnt(8)
  v_mfma_f32_16x16x32_bf16 v[4:7], v[92:95], v[80:83], v[4:7]
  v_pk_ashrrev_i16 v123, 15, v119 op_sel_hi:[0,1]
  v_and_b32_dpp v76, v29, v120 row_newbcast:8 row_mask:0xf bank_mask:0xf
  v_and_b32_dpp v77, v29, v121 row_newbcast:9 row_mask:0xf bank_mask:0xf
  v_and_b32_dpp v78, v29, v122 row_newbcast:10 row_mask:0xf bank_mask:0xf
  v_and_b32_dpp v79, v29, v123 row_newbcast:11 row_mask:0xf bank_mask:0xf
  s_waitcnt lgkmcnt(6)
  v_mfma_f32_16x16x32_bf16 v[8:11], v[96:99], v[80:83], v[8:11]
  v_lshlrev_b64 v[116:117], 6, v[30:31]
  v_pk_ashrrev_i16 v120, 15, v116 op_sel_hi:[0,1]
  v_pk_ashrrev_i16 v121, 15, v117 op_sel_hi:[0,1]
  s_waitcnt lgkmcnt(4)
  v_mfma_f32_16x16x32_bf16 v[4:7], v[100:103], v[76:79], v[4:7]
  v_and_b32_dpp v80, v29, v120 row_newbcast:12 row_mask:0xf bank_mask:0xf
  v_and_b32_dpp v81, v29, v121 row_newbcast:13 row_mask:0xf bank_mask:0xf
  s_waitcnt lgkmcnt(2)
  v_mfma_f32_16x16x32_bf16 v[8:11], v[104:107], v[76:79], v[8:11]
  s_waitcnt lgkmcnt(1)
  s_nop 0
  v_mfma_f32_16x16x16_bf16 v[4:7], v[108:109], v[80:81], v[4:7]
  s_waitcnt lgkmcnt(0)
  v_mfma_f32_16x16x16_bf16 v[8:11], v[112:113], v[80:81], v[8:11]
  s_branch L_donea1
L_slowa1:
  s_mul_i32 s25, s24, 10223616
  s_add_u32 s25, s25, s17
  s_add_u32 s25, s25, 0
  buffer_load_dwordx3 v[28:30], v59, s[4:7], s25 offen
  s_waitcnt vmcnt(0)
  s_branch L_blka1
L_morea1:
  s_add_u32 s24, s24, 1
  s_cmp_lg_u32 s24, 1
  s_cbranch_scc1 L_slowa1
  v_mov_b32 v28, v52
  v_mov_b32 v29, v53
  v_mov_b32 v30, v54
  s_branch L_blka1
L_v4a1:
  v_lshrrev_b32 v121, 16, v28
  v_and_b32 v120, 0xffff, v28
  v_lshlrev_b32 v31, 8, v30
  s_nop 0
  v_add_u32_dpp v76, v120, v55 quad_perm:[0,0,0,0] row_mask:0xf bank_mask:0xf
  v_add_u32_dpp v77, v121, v55 quad_perm:[0,0,0,0] row_mask:0xf bank_mask:0xf
  ds_read_b64_tr_b16 v[84:85], v76 offset:0
  ds_read_b64_tr_b16 v[86:87], v77 offset:0
  ds_read_b64_tr_b16 v[88:89], v76 offset:40960
  ds_read_b64_tr_b16 v[90:91], v77 offset:40960
  v_add_u32_dpp v78, v120, v55 quad_perm:[1,1,1,1] row_mask:0xf bank_mask:0xf
  v_add_u32_dpp v79, v121, v55 quad_perm:[1,1,1,1] row_mask:0xf bank_mask:0xf
  ds_read_b64_tr_b16 v[92:93], v78 offset:0
  ds_read_b64_tr_b16 v[94:95], v79 offset:0
  ds_read_b64_tr_b16 v[96:97], v78 offset:40960
  ds_read_b64_tr_b16 v[98:99], v79 offset:40960
  v_add_u32_dpp v80, v120, v55 quad_perm:[2,2,2,2] row_mask:0xf bank_mask:0xf
  v_add_u32_dpp v81, v121, v55 quad_perm:[2,2,2,2] row_mask:0xf bank_mask:0xf
  ds_read_b64_tr_b16 v[100:101], v80 offset:0
  ds_read_b64_tr_b16 v[102:103], v81 offset:0
  ds_read_b64_tr_b16 v[104:105], v80 offset:40960
  ds_read_b64_tr_b16 v[106:107], v81 offset:40960
  v_add_u32_dpp v82, v120, v55 quad_perm:[3,3,3,3] row_mask:0xf bank_mask:0xf
  v_add_u32_dpp v83, v121, v55 quad_perm:[3,3,3,3] row_mask:0xf bank_mask:0xf
  ds_read_b64_tr_b16 v[108:109], v82 offset:0
  ds_read_b64_tr_b16 v[110:111], v83 offset:0
  ds_read_b64_tr_b16 v[112:113], v82 offset:40960
  ds_read_b64_tr_b16 v[114:115], v83 offset:40960
  v_lshlrev_b64 v[118:119], 1, v[30:31]
  v_pk_ashrrev_i16 v120, 15, v30 op_sel_hi:[0,1]
  v_pk_ashrrev_i16 v121, 15, v31 op_sel_hi:[0,1]
  v_pk_ashrrev_i16 v122, 15, v118 op_sel_hi:[0,1]
  v_pk_ashrrev_i16 v123, 15, v119 op_sel_hi:[0,1]
  v_and_b32_dpp v76, v29, v120 row_newbcast:0 row_mask:0xf bank_mask:0xf
  v_and_b32_dpp v77, v29, v121 row_newbcast:1 row_mask:0xf bank_mask:0xf
  v_and_b32_dpp v78, v29, v122 row_newbcast:2 row_mask:0xf bank_mask:0xf
  v_and_b32_dpp v79, v29, v123 row_newbcast:3 row_mask:0xf bank_mask:0xf
  v_lshlrev_b64 v[116:117], 2, v[30:31]
  v_lshlrev_b64 v[118:119], 3, v[30:31]
  v_pk_ashrrev_i16 v120, 15, v116 op_sel_hi:[0,1]
  v_pk_ashrrev_i16 v121, 15, v117 op_sel_hi:[0,1]
  v_pk_ashrrev_i16 v122, 15, v118 op_sel_hi:[0,1]
  s_waitcnt lgkmcnt(14)
  v_mfma_f32_16x16x32_bf16 v[4:7], v[84:87], v[76:79], v[4:7]
  v_pk_ashrrev_i16 v123, 15, v119 op_sel_hi:[0,1]
  v_and_b32_dpp v80, v29, v120 row_newbcast:4 row_mask:0xf bank_mask:0xf
  v_and_b32_dpp v81, v29, v121 row_newbcast:5 row_mask:0xf bank_mask:0xf
  v_and_b32_dpp v82, v29, v122 row_newbcast:6 row_mask:0xf bank_mask:0xf
  v_and_b32_dpp v83, v29, v123 row_newbcast:7 row_mask:0xf bank_mask:0xf
  s_waitcnt lgkmcnt(12)
  v_mfma_f32_16x16x32_bf16 v[8:11], v[88:91], v[76:79], v[8:11]
  v_lshlrev_b64 v[116:117], 4, v[30:31]
  v_lshlrev_b64 v[118:119], 5, v[30:31]
  v_pk_ashrrev_i16 v120, 15, v116 op_sel_hi:[0,1]
  v_pk_ashrrev_i16 v121, 15, v117 op_sel_hi:[0,1]
  v_pk_ashrrev_i16 v122, 15, v118 op_sel_hi:[0,1]
  s_waitcnt lgkmcnt(10)
  v_mfma_f32_16x16x32_bf16 v[4:7], v[92:95], v[80:83], v[4:7]
  v_pk_ashrrev_i16 v123, 15, v119 op_sel_hi:[0,1]
  v_and_b32_dpp v76, v29, v120 row_newbcast:8 row_mask:0xf bank_mask:0xf
  v_and_b32_dpp v77, v29, v121 row_newbcast:9 row_mask:0xf bank_mask:0xf
  v_and_b32_dpp v78, v29, v122 row_newbcast:10 row_mask:0xf bank_mask:0xf
  v_and_b32_dpp v79, v29, v123 row_newbcast:11 row_mask:0xf bank_mask:0xf
  s_waitcnt lgkmcnt(8)
  v_mfma_f32_16x16x32_bf16 v[8:11], v[96:99], v[80:83], v[8:11]
  v_lshlrev_b64 v[116:117], 6, v[30:31]
  v_lshlrev_b64 v[118:119], 7, v[30:31]
  v_pk_ashrrev_i16 v120, 15, v116 op_sel_hi:[0,1]
  v_pk_ashrrev_i16 v121, 15, v117 op_sel_hi:[0,1]
  v_pk_ashrrev_i16 v122, 15, v118 op_sel_hi:[0,1]
  s_waitcnt lgkmcnt(6)
  v_mfma_f32_16x16x32_bf16 v[4:7], v[100:103], v[76:79], v[4:7]
  v_pk_ashrrev_i16 v123, 15, v119 op_sel_hi:[0,1]
  v_and_b32_dpp v80, v29, v120 row_newbcast:12 row_mask:0xf bank_mask:0xf
  v_and_b32_dpp v81, v29, v121 row_newbcast:13 row_mask:0xf bank_mask:0xf
  v_and_b32_dpp v82, v29, v122 row_newbcast:14 row_mask:0xf bank_mask:0xf
  v_and_b32_dpp v83, v29, v123 row_newbcast:15 row_mask:0xf bank_mask:0xf
  s_waitcnt lgkmcnt(4)
  v_mfma_f32_16x16x32_bf16 v[8:11], v[104:107], v[76:79], v[8:11]
  s_waitcnt lgkmcnt(2)
  s_nop 0
  v_mfma_f32_16x16x32_bf16 v[4:7], v[108:111], v[80:83], v[4:7]
  s_waitcnt lgkmcnt(0)
  v_mfma_f32_16x16x32_bf16 v[8:11], v[112:115], v[80:83], v[8:11]
  s_sub_u32 s20, s20, 8
  s_cmp_lg_u32 s20, 0
  s_cbranch_scc1 L_morea1
L_donea1:
  s_add_u32 s26, s16, 2
  s_add_u32 s25, s17, 1536
  v_readlane_b32 s20, v63, s26
  buffer_load_dwordx3 v[28:30], v59, s[4:7], s25 offen
  s_cmp_le_u32 s20, 8
  s_cbranch_scc1 L_nfa1
  s_add_u32 s25, s25, 10223616
  buffer_load_dwordx3 v[52:54], v59, s[4:7], s25 offen
L_nfa1:
  s_setprio 1
  s_mov_b32 s24, 0
L_blkb1:
  s_cmp_ge_u32 s21, 8
  s_cbranch_scc1 L_v4b1
  s_cmp_eq_u32 s21, 7
  s_cbranch_scc1 L_w7b1
  s_cmp_eq_u32 s21, 6
  s_cbranch_scc1 L_w6b1
  s_cmp_eq_u32 s21, 5
  s_cbranch_scc1 L_w5b1
  s_cmp_eq_u32 s21, 4
  s_cbranch_scc1 L_w4b1
  s_cmp_eq_u32 s21, 3
  s_cbranch_scc1 L_w3b1
  s_cmp_eq_u32 s21, 2
  s_cbranch_scc1 L_w2b1
  s_cmp_eq_u32 s21, 0
  s_cbranch_scc1 L_doneb1
L_w1b1:
  v_and_b32 v120, 0xffff, v32
  v_lshlrev_b32 v35, 8, v34
  s_nop 0
  v_add_u32_dpp v76, v120, v55 quad_perm:[0,0,0,0] row_mask:0xf bank_mask:0xf
  ds_read_b64_tr_b16 v[84:85], v76 offset:0
  ds_read_b64_tr_b16 v[88:89], v76 offset:40960
  v_pk_ashrrev_i16 v120, 15, v34 op_sel_hi:[0,1]
  v_pk_ashrrev_i16 v121, 15, v35 op_sel_hi:[0,1]
  v_and_b32_dpp v76, v33, v120 row_newbcast:0 row_mask:0xf bank_mask:0xf
  v_and_b32_dpp v77, v33, v121 row_newbcast:1 row_mask:0xf bank_mask:0xf
  s_waitcnt lgkmcnt(1)
  s_nop 0
  v_mfma_f32_16x16x16_bf16 v[12:15], v[84:85], v[76:77], v[12:15]
  s_waitcnt lgkmcnt(0)
  v_mfma_f32_16x16x16_bf16 v[16:19], v[88:89], v[76:77], v[16:19]
  s_branch L_doneb1
L_w2b1:
  v_lshrrev_b32 v121, 16, v32
  v_and_b32 v120, 0xffff, v32
  v_lshlrev_b32 v35, 8, v34
  s_nop 0
  v_add_u32_dpp v76, v120, v55 quad_perm:[0,0,0,0] row_mask:0xf bank_mask:0xf
  v_add_u32_dpp v77, v121, v55 quad_perm:[0,0,0,0] row_mask:0xf bank_mask:0xf
  ds_read_b64_tr_b16 v[84:85], v76 offset:0
  ds_read_b64_tr_b16 v[86:87], v77 offset:0
  ds_read_b64_tr_b16 v[88:89], v76 offset:40960
  ds_read_b64_tr_b16 v[90:91], v77 offset:40960
  v_lshlrev_b64 v[118:119], 1, v[34:35]
  v_pk_ashrrev_i16 v120, 15, v34 op_sel_hi:[0,1]
  v_pk_ashrrev_i16 v121, 15, v35 op_sel_hi:[0,1]
  v_pk_ashrrev_i16 v122, 15, v118 op_sel_hi:[0,1]
  v_pk_ashrrev_i16 v123, 15, v119 op_sel_hi:[0,1]
  v_and_b32_dpp v76, v33, v120 row_newbcast:0 row_mask:0xf bank_mask:0xf
  v_and_b32_dpp v77, v33, v121 row_newbcast:1 row_mask:0xf bank_mask:0xf
  v_and_b32_dpp v78, v33, v122 row_newbcast:2 row_mask:0xf bank_mask:0xf
  v_and_b32_dpp v79, v33, v123 row_newbcast:3 row_mask:0xf bank_mask:0xf
  s_waitcnt lgkmcnt(2)
  s_nop 0
  v_mfma_f32_16x16x32_bf16 v[12:15], v[84:87], v[76:79], v[12:15]
  s_waitcnt lgkmcnt(0)
  v_mfma_f32_16x16x32_bf16 v[16:19], v[88:91], v[76:79], v[16:19]
  s_branch L_doneb1
L_w3b1:
  v_lshrrev_b32 v121, 16, v32
  v_and_b32 v120, 0xffff, v32
  v_lshlrev_b32 v35, 8, v34
  s_nop 0
  v_add_u32_dpp v76, v120, v55 quad_perm:[0,0,0,0] row_mask:0xf bank_mask:0xf
  v_add_u32_dpp v77, v121, v55 quad_perm:[0,0,0,0] row_mask:0xf bank_mask:0xf
  ds_read_b64_tr_b16 v[84:85], v76 offset:0
  ds_read_b64_tr_b16 v[86:87], v77 offset:0
  ds_read_b64_tr_b16 v[88:89], v76 offset:40960
  ds_read_b64_tr_b16 v[90:91], v77 offset:40960
  v_add_u32_dpp v78, v120, v55 quad_perm:[1,1,1,1] row_mask:0xf bank_mask:0xf
  ds_read_b64_tr_b16 v[92:93], v78 offset:0
  ds_read_b64_tr_b16 v[96:97], v78 offset:40960
  v_lshlrev_b64 v[118:119], 1, v[34:35]
  v_pk_ashrrev_i16 v120, 15, v34 op_sel_hi:[0,1]
  v_pk_ashrrev_i16 v121, 15, v35 op_sel_hi:[0,1]
  v_pk_ashrrev_i16 v122, 15, v118 op_sel_hi:[0,1]
  v_pk_ashrrev_i16 v123, 15, v119 op_sel_hi:[0,1]
  v_and_b32_dpp v76, v33, v120 row_newbcast:0 row_mask:0xf bank_mask:0xf
  v_and_b32_dpp v77, v33, v121 row_newbcast:1 row_mask:0xf bank_mask:0xf
  v_and_b32_dpp v78, v33, v122 row_newbcast:2 row_mask:0xf bank_mask:0xf
  v_and_b32_dpp v79, v33, v123 row_newbcast:3 row_mask:0xf bank_mask:0xf
  v_lshlrev_b64 v[116:117], 2, v[34:35]
  v_pk_ashrrev_i16 v120, 15, v116 op_sel_hi:[0,1]
  v_pk_ashrrev_i16 v121, 15, v117 op_sel_hi:[0,1]
  s_waitcnt lgkmcnt(4)
  v_mfma_f32_16x16x32_bf16 v[12:15], v[84:87], v[76:79], v[12:15]
  v_and_b32_dpp v80, v33, v120 row_newbcast:4 row_mask:0xf bank_mask:0xf
  v_and_b32_dpp v81, v33, v121 row_newbcast:5 row_mask:0xf bank_mask:0xf
  s_waitcnt lgkmcnt(2)
  v_mfma_f32_16x16x32_bf16 v[16:19], v[88:91], v[76:79], v[16:19]
  s_waitcnt lgkmcnt(1)
  s_nop 0
  v_mfma_f32_16x16x16_bf16 v[12:15], v[92:93], v[80:81], v[12:15]
  s_waitcnt lgkmcnt(0)
  v_mfma_f32_16x16x16_bf16 v[16:19], v[96:97], v[80:81], v[16:19]
  s_branch L_doneb1
L_w4b1:
  v_lshrrev_b32 v121, 16, v32
  v_and_b32 v120, 0xffff, v32
  v_lshlrev_b32 v35, 8, v34
  s_nop 0
  v_add_u32_dpp v76, v120, v55 quad_perm:[0,0,0,0] row_mask:0xf bank_mask:0xf
  v_add_u32_dpp v77, v121, v55 quad_perm:[0,0,0,0] row_mask:0xf bank_mask:0xf
  ds_read_b64_tr_b16 v[84:85], v76 offset:0
  ds_read_b64_tr_b16 v[86:87], v77 offset:0
  ds_read_b64_tr_b16 v[88:89], v76 offset:40960
  ds_read_b64_tr_b16 v[90:91], v77 offset:40960
  v_add_u32_dpp v78, v120, v55 quad_perm:[1,1,1,1] row_mask:0xf bank_mask:0xf
  v_add_u32_dpp v79, v121, v55 quad_perm:[1,1,1,1] row_mask:0xf bank_mask:0xf
  ds_read_b64_tr_b16 v[92:93], v78 offset:0
  ds_read_b64_tr_b16 v[94:95], v79 offset:0
  ds_read_b64_tr_b16 v[96:97], v78 offset:40960
  ds_read_b64_tr_b16 v[98:99], v79 offset:40960
  v_lshlrev_b64 v[118:119], 1, v[34:35]
  v_pk_ashrrev_i16 v120, 15, v34 op_sel_hi:[0,1]
  v_pk_ashrrev_i16 v121, 15, v35 op_sel_hi:[0,1]
  v_pk_ashrrev_i16 v122, 15, v118 op_sel_hi:[0,1]
  v_pk_ashrrev_i16 v123, 15, v119 op_sel_hi:[0,1]
  v_and_b32_dpp v76, v33, v120 row_newbcast:0 row_mask:0xf bank_mask:0xf
  v_and_b32_dpp v77, v33, v121 row_newbcast:1 row_mask:0xf bank_mask:0xf
  v_and_b32_dpp v78, v33, v122 row_newbcast:2 row_mask:0xf bank_mask:0xf
  v_and_b32_dpp v79, v33, v123 row_newbcast:3 row_mask:0xf bank_mask:0xf
  v_lshlrev_b64 v[116:117], 2, v[34:35]
  v_lshlrev_b64 v[118:119], 3, v[34:35]
  v_pk_ashrrev_i16 v120, 15, v116 op_sel_hi:[0,1]
  v_pk_ashrrev_i16 v121, 15, v117 op_sel_hi:[0,1]
  v_pk_ashrrev_i16 v122, 15, v118 op_sel_hi:[0,1]
  s_waitcnt lgkmcnt(6)
  v_mfma_f32_16x16x32_bf16 v[12:15], v[84:87], v[76:79], v[12:15]
  v_pk_ashrrev_i16 v123, 15, v119 op_sel_hi:[0,1]
  v_and_b32_dpp v80, v33, v120 row_newbcast:4 row_mask:0xf bank_mask:0xf
  v_and_b32_dpp v81, v33, v121 row_newbcast:5 row_mask:0xf bank_mask:0xf
  v_and_b32_dpp v82, v33, v122 row_newbcast:6 row_mask:0xf bank_mask:0xf
  v_and_b32_dpp v83, v33, v123 row_newbcast:7 row_mask:0xf bank_mask:0xf
  s_waitcnt lgkmcnt(4)
  v_mfma_f32_16x16x32_bf16 v[16:19], v[88:91], v[76:79], v[16:19]
  s_waitcnt lgkmcnt(2)
  s_nop 0
  v_mfma_f32_16x16x32_bf16 v[12:15], v[92:95], v[80:83], v[12:15]
  s_waitcnt lgkmcnt(0)
  v_mfma_f32_16x16x32_bf16 v[16:19], v[96:99], v[80:83], v[16:19]
  s_branch L_doneb1
L_w5b1:
  v_lshrrev_b32 v121, 16, v32
  v_and_b32 v120, 0xffff, v32
  v_lshlrev_b32 v35, 8, v34
  s_nop 0
  v_add_u32_dpp v76, v120, v55 quad_perm:[0,0,0,0] row_mask:0xf bank_mask:0xf
  v_add_u32_dpp v77, v121, v55 quad_perm:[0,0,0,0] row_mask:0xf bank_mask:0xf
  ds_read_b64_tr_b16 v[84:85], v76 offset:0
  ds_read_b64_tr_b16 v[86:87], v77 offset:0
  ds_read_b64_tr_b16 v[88:89], v76 offset:40960
  ds_read_b64_tr_b16 v[90:91], v77 offset:40960
  v_add_u32_dpp v78, v120, v55 quad_perm:[1,1,1,1] row_mask:0xf bank_mask:0xf
  v_add_u32_dpp v79, v121, v55 quad_perm:[1,1,1,1] row_mask:0xf bank_mask:0xf
  ds_read_b64_tr_b16 v[92:93], v78 offset:0
  ds_read_b64_tr_b16 v[94:95], v79 offset:0
  ds_read_b64_tr_b16 v[96:97], v78 offset:40960
  ds_read_b64_tr_b16 v[98:99], v79 offset:40960
  v_add_u32_dpp v80, v120, v55 quad_perm:[2,2,2,2] row_mask:0xf bank_mask:0xf
  ds_read_b64_tr_b16 v[100:101], v80 offset:0
  ds_read_b64_tr_b16 v[104:105], v80 offset:40960
  v_lshlrev_b64 v[118:119], 1, v[34:35]
  v_pk_ashrrev_i16 v120, 15, v34 op_sel_hi:[0,1]
  v_pk_ashrrev_i16 v121, 15, v35 op_sel_hi:[0,1]
  v_pk_ashrrev_i16 v122, 15, v118 op_sel_hi:[0,1]
  v_pk_ashrrev_i16 v123, 15, v119 op_sel_hi:[0,1]
  v_and_b32_dpp v76, v33, v120 row_newbcast:0 row_mask:0xf bank_mask:0xf
  v_and_b32_dpp v77, v33, v121 row_newbcast:1 row_mask:0xf bank_mask:0xf
  v_and_b32_dpp v78, v33, v122 row_newbcast:2 row_mask:0xf bank_mask:0xf
  v_and_b32_dpp v79, v33, v123 row_newbcast:3 row_mask:0xf bank_mask:0xf
  v_lshlrev_b64 v[116:117], 2, v[34:35]
  v_lshlrev_b64 v[118:119], 3, v[34:35]
  v_pk_ashrrev_i16 v120, 15, v116 op_sel_hi:[0,1]
  v_pk_ashrrev_i16 v121, 15, v117 op_sel_hi:[0,1]
  v_pk_ashrrev_i16 v122, 15, v118 op_sel_hi:[0,1]
  s_waitcnt lgkmcnt(8)
  v_mfma_f32_16x16x32_bf16 v[12:15], v[84:87], v[76:79], v[12:15]
  v_pk_ashrrev_i16 v123, 15, v119 op_sel_hi:[0,1]
  v_and_b32_dpp v80, v33, v120 row_newbcast:4 row_mask:0xf bank_mask:0xf
  v_and_b32_dpp v81, v33, v121 row_newbcast:5 row_mask:0xf bank_mask:0xf
  v_and_b32_dpp v82, v33, v122 row_newbcast:6 row_mask:0xf bank_mask:0xf
  v_and_b32_dpp v83, v33, v123 row_newbcast:7 row_mask:0xf bank_mask:0xf
  s_waitcnt lgkmcnt(6)
  v_mfma_f32_16x16x32_bf16 v[16:19], v[88:91], v[76:79], v[16:19]
  v_lshlrev_b64 v[116:117], 4, v[34:35]
  v_pk_ashrrev_i16 v120, 15, v116 op_sel_hi:[0,1]
  v_pk_ashrrev_i16 v121, 15, v117 op_sel_hi:[0,1]
  s_waitcnt lgkmcnt(4)
  v_mfma_f32_16x16x32_bf16 v[12:15], v[92:95], v[80:83], v[12:15]
  v_and_b32_dpp v76, v33, v120 row_newbcast:8 row_mask:0xf bank_mask:0xf
  v_and_b32_dpp v77, v33, v121 row_newbcast:9 row_mask:0xf bank_mask:0xf
  s_waitcnt lgkmcnt(2)
  v_mfma_f32_16x16x32_bf16 v[16:19], v[96:99], v[80:83], v[16:19]
  s_waitcnt lgkmcnt(1)
  s_nop 0
  v_mfma_f32_16x16x16_bf16 v[12:15], v[100:101], v[76:77], v[12:15]
  s_waitcnt lgkmcnt(0)
  v_mfma_f32_16x16x16_bf16 v[16:19], v[104:105], v[76:77], v[16:19]
  s_branch L_doneb1
L_w6b1:
  v_lshrrev_b32 v121, 16, v32
  v_and_b32 v120, 0xffff, v32
  v_lshlrev_b32 v35, 8, v34
  s_nop 0
  v_add_u32_dpp v76, v120, v55 quad_perm:[0,0,0,0] row_mask:0xf bank_mask:0xf
  v_add_u32_dpp v77, v121, v55 quad_perm:[0,0,0,0] row_mask:0xf bank_mask:0xf
  ds_read_b64_tr_b16 v[84:85], v76 offset:0
  ds_read_b64_tr_b16 v[86:87], v77 offset:0
  ds_read_b64_tr_b16 v[88:89], v76 offset:40960
  ds_read_b64_tr_b16 v[90:91], v77 offset:40960
  v_add_u32_dpp v78, v120, v55 quad_perm:[1,1,1,1] row_mask:0xf bank_mask:0xf
  v_add_u32_dpp v79, v121, v55 quad_perm:[1,1,1,1] row_mask:0xf bank_mask:0xf
  ds_read_b64_tr_b16 v[92:93], v78 offset:0
  ds_read_b64_tr_b16 v[94:95], v79 offset:0
  ds_read_b64_tr_b16 v[96:97], v78 offset:40960
  ds_read_b64_tr_b16 v[98:99], v79 offset:40960
  v_add_u32_dpp v80, v120, v55 quad_perm:[2,2,2,2] row_mask:0xf bank_mask:0xf
  v_add_u32_dpp v81, v121, v55 quad_perm:[2,2,2,2] row_mask:0xf bank_mask:0xf
  ds_read_b64_tr_b16 v[100:101], v80 offset:0
  ds_read_b64_tr_b16 v[102:103], v81 offset:0
  ds_read_b64_tr_b16 v[104:105], v80 offset:40960
  ds_read_b64_tr_b16 v[106:107], v81 offset:40960
  v_lshlrev_b64 v[118:119], 1, v[34:35]
  v_pk_ashrrev_i16 v120, 15, v34 op_sel_hi:[0,1]
  v_pk_ashrrev_i16 v121, 15, v35 op_sel_hi:[0,1]
  v_pk_ashrrev_i16 v122, 15, v118 op_sel_hi:[0,1]
  v_pk_ashrrev_i16 v123, 15, v119 op_sel_hi:[0,1]
  v_and_b32_dpp v76, v33, v120 row_newbcast:0 row_mask:0xf bank_mask:0xf
  v_and_b32_dpp v77, v33, v121 row_newbcast:1 row_mask:0xf bank_mask:0xf
  v_and_b32_dpp v78, v33, v122 row_newbcast:2 row_mask:0xf bank_mask:0xf
  v_and_b32_dpp v79, v33, v123 row_newbcast:3 row_mask:0xf bank_mask:0xf
  v_lshlrev_b64 v[116:117], 2, v[34:35]
  v_lshlrev_b64 v[118:119], 3, v[34:35]
  v_pk_ashrrev_i16 v120, 15, v116 op_sel_hi:[0,1]
  v_pk_ashrrev_i16 v121, 15, v117 op_sel_hi:[0,1]
  v_pk_ashrrev_i16 v122, 15, v118 op_sel_hi:[0,1]
  s_waitcnt lgkmcnt(10)
  v_mfma_f32_16x16x32_bf16 v[12:15], v[84:87], v[76:79], v[12:15]
  v_pk_ashrrev_i16 v123, 15, v119 op_sel_hi:[0,1]
  v_and_b32_dpp v80, v33, v120 row_newbcast:4 row_mask:0xf bank_mask:0xf
  v_and_b32_dpp v81, v33, v121 row_newbcast:5 row_mask:0xf bank_mask:0xf
  v_and_b32_dpp v82, v33, v122 row_newbcast:6 row_mask:0xf bank_mask:0xf
  v_and_b32_dpp v83, v33, v123 row_newbcast:7 row_mask:0xf bank_mask:0xf
  s_waitcnt lgkmcnt(8)
  v_mfma_f32_16x16x32_bf16 v[16:19], v[88:91], v[76:79], v[16:19]
  v_lshlrev_b64 v[116:117], 4, v[34:35]
  v_lshlrev_b64 v[118:119], 5, v[34:35]
  v_pk_ashrrev_i16 v120, 15, v116 op_sel_hi:[0,1]
  v_pk_ashrrev_i16 v121, 15, v117 op_sel_hi:[0,1]
  v_pk_ashrrev_i16 v122, 15, v118 op_sel_hi:[0,1]
  s_waitcnt lgkmcnt(6)
  v_mfma_f32_16x16x32_bf16 v[12:15], v[92:95], v[80:83], v[12:15]
  v_pk_ashrrev_i16 v123, 15, v119 op_sel_hi:[0,1]
  v_and_b32_dpp v76, v33, v120 row_newbcast:8 row_mask:0xf bank_mask:0xf
  v_and_b32_dpp v77, v33, v121 row_newbcast:9 row_mask:0xf bank_mask:0xf
  v_and_b32_dpp v78, v33, v122 row_newbcast:10 row_mask:0xf bank_mask:0xf
  v_and_b32_dpp v79, v33, v123 row_newbcast:11 row_mask:0xf bank_mask:0xf
  s_waitcnt lgkmcnt(4)
  v_mfma_f32_16x16x32_bf16 v[16:19], v[96:99], v[80:83], v[16:19]
  s_waitcnt lgkmcnt(2)
  s_nop 0
  v_mfma_f32_16x16x32_bf16 v[12:15], v[100:103], v[76:79], v[12:15]
  s_waitcnt lgkmcnt(0)
  v_mfma_f32_16x16x32_bf16 v[16:19], v[104:107], v[76:79], v[16:19]
  s_branch L_doneb1
L_w7b1:
  v_lshrrev_b32 v121, 16, v32
  v_and_b32 v120, 0xffff, v32
  v_lshlrev_b32 v35, 8, v34
  s_nop 0
  v_add_u32_dpp v76, v120, v55 quad_perm:[0,0,0,0] row_mask:0xf bank_mask:0xf
  v_add_u32_dpp v77, v121, v55 quad_perm:[0,0,0,0] row_mask:0xf bank_mask:0xf
  ds_read_b64_tr_b16 v[84:85], v76 offset:0
  ds_read_b64_tr_b16 v[86:87], v77 offset:0
  ds_read_b64_tr_b16 v[88:89], v76 offset:40960
  ds_read_b64_tr_b16 v[90:91], v77 offset:40960
  v_add_u32_dpp v78, v120, v55 quad_perm:[1,1,1,1] row_mask:0xf bank_mask:0xf
  v_add_u32_dpp v79, v121, v55 quad_perm:[1,1,1,1] row_mask:0xf bank_mask:0xf
  ds_read_b64_tr_b16 v[92:93], v78 offset:0
  ds_read_b64_tr_b16 v[94:95], v79 offset:0
  ds_read_b64_tr_b16 v[96:97], v78 offset:40960
  ds_read_b64_tr_b16 v[98:99], v79 offset:40960
  v_add_u32_dpp v80, v120, v55 quad_perm:[2,2,2,2] row_mask:0xf bank_mask:0xf
  v_add_u32_dpp v81, v121, v55 quad_perm:[2,2,2,2] row_mask:0xf bank_mask:0xf
  ds_read_b64_tr_b16 v[100:101], v80 offset:0
  ds_read_b64_tr_b16 v[102:103], v81 offset:0
  ds_read_b64_tr_b16 v[104:105], v80 offset:40960
  ds_read_b64_tr_b16 v[106:107], v81 offset:40960
  v_add_u32_dpp v82, v120, v55 quad_perm:[3,3,3,3] row_mask:0xf bank_mask:0xf
  ds_read_b64_tr_b16 v[108:109], v82 offset:0
  ds_read_b64_tr_b16 v[112:113], v82 offset:40960
  v_lshlrev_b64 v[118:119], 1, v[34:35]
  v_pk_ashrrev_i16 v120, 15, v34 op_sel_hi:[0,1]
  v_pk_ashrrev_i16 v121, 15, v35 op_sel_hi:[0,1]
  v_pk_ashrrev_i16 v122, 15, v118 op_sel_hi:[0,1]
  v_pk_ashrrev_i16 v123, 15, v119 op_sel_hi:[0,1]
  v_and_b32_dpp v76, v33, v120 row_newbcast:0 row_mask:0xf bank_mask:0xf
  v_and_b32_dpp v77, v33, v121 row_newbcast:1 row_mask:0xf bank_mask:0xf
  v_and_b32_dpp v78, v33, v122 row_newbcast:2 row_mask:0xf bank_mask:0xf
  v_and_b32_dpp v79, v33, v123 row_newbcast:3 row_mask:0xf bank_mask:0xf
  v_lshlrev_b64 v[116:117], 2, v[34:35]
  v_lshlrev_b64 v[118:119], 3, v[34:35]
  v_pk_ashrrev_i16 v120, 15, v116 op_sel_hi:[0,1]
  v_pk_ashrrev_i16 v121, 15, v117 op_sel_hi:[0,1]
  v_pk_ashrrev_i16 v122, 15, v118 op_sel_hi:[0,1]
  s_waitcnt lgkmcnt(12)
  v_mfma_f32_16x16x32_bf16 v[12:15], v[84:87], v[76:79], v[12:15]
  v_pk_ashrrev_i16 v123, 15, v119 op_sel_hi:[0,1]
  v_and_b32_dpp v80, v33, v120 row_newbcast:4 row_mask:0xf bank_mask:0xf
  v_and_b32_dpp v81, v33, v121 row_newbcast:5 row_mask:0xf bank_mask:0xf
  v_and_b32_dpp v82, v33, v122 row_newbcast:6 row_mask:0xf bank_mask:0xf
  v_and_b32_dpp v83, v33, v123 row_newbcast:7 row_mask:0xf bank_mask:0xf
  s_waitcnt lgkmcnt(10)
  v_mfma_f32_16x16x32_bf16 v[16:19], v[88:91], v[76:79], v[16:19]
  v_lshlrev_b64 v[116:117], 4, v[34:35]
  v_lshlrev_b64 v[118:119], 5, v[34:35]
  v_pk_ashrrev_i16 v120, 15, v116 op_sel_hi:[0,1]
  v_pk_ashrrev_i16 v121, 15, v117 op_sel_hi:[0,1]
  v_pk_ashrrev_i16 v122, 15, v118 op_sel_hi:[0,1]
  s_waitcnt lgkmcnt(8)
  v_mfma_f32_16x16x32_bf16 v[12:15], v[92:95], v[80:83], v[12:15]
  v_pk_ashrrev_i16 v123, 15, v119 op_sel_hi:[0,1]
  v_and_b32_dpp v76, v33, v120 row_newbcast:8 row_mask:0xf bank_mask:0xf
  v_and_b32_dpp v77, v33, v121 row_newbcast:9 row_mask:0xf bank_mask:0xf
  v_and_b32_dpp v78, v33, v122 row_newbcast:10 row_mask:0xf bank_mask:0xf
  v_and_b32_dpp v79, v33, v123 row_newbcast:11 row_mask:0xf bank_mask:0xf
  s_waitcnt lgkmcnt(6)
  v_mfma_f32_16x16x32_bf16 v[16:19], v[96:99], v[80:83], v[16:19]
  v_lshlrev_b64 v[116:117], 6, v[34:35]
  v_pk_ashrrev_i16 v120, 15, v116 op_sel_hi:[0,1]
  v_pk_ashrrev_i16 v121, 15, v117 op_sel_hi:[0,1]
  s_waitcnt lgkmcnt(4)
  v_mfma_f32_16x16x32_bf16 v[12:15], v[100:103], v[76:79], v[12:15]
  v_and_b32_dpp v80, v33, v120 row_newbcast:12 row_mask:0xf bank_mask:0xf
  v_and_b32_dpp v81, v33, v121 row_newbcast:13 row_mask:0xf bank_mask:0xf
  s_waitcnt lgkmcnt(2)
  v_mfma_f32_16x16x32_bf16 v[16:19], v[104:107], v[76:79], v[16:19]
  s_waitcnt lgkmcnt(1)
  s_nop 0
  v_mfma_f32_16x16x16_bf16 v[12:15], v[108:109], v[80:81], v[12:15]
  s_waitcnt lgkmcnt(0)
  v_mfma_f32_16x16x16_bf16 v[16:19], v[112:113], v[80:81], v[16:19]
  s_branch L_doneb1
L_slowb1:
  s_mul_i32 s25, s24, 10223616
  s_add_u32 s25, s25, s17
  s_add_u32 s25, s25, 119808
  buffer_load_dwordx3 v[32:34], v59, s[4:7], s25 offen
  s_waitcnt vmcnt(0)
  s_branch L_blkb1
L_moreb1:
  s_add_u32 s24, s24, 1
  s_cmp_lg_u32 s24, 1
  s_cbranch_scc1 L_slowb1
  v_mov_b32 v32, v56
  v_mov_b32 v33, v57
  v_mov_b32 v34, v58
  s_branch L_blkb1
L_v4b1:
  v_lshrrev_b32 v121, 16, v32
  v_and_b32 v120, 0xffff, v32
  v_lshlrev_b32 v35, 8, v34
  s_nop 0
  v_add_u32_dpp v76, v120, v55 quad_perm:[0,0,0,0] row_mask:0xf bank_mask:0xf
  v_add_u32_dpp v77, v121, v55 quad_perm:[0,0,0,0] row_mask:0xf bank_mask:0xf
  ds_read_b64_tr_b16 v[84:85], v76 offset:0
  ds_read_b64_tr_b16 v[86:87], v77 offset:0
  ds_read_b64_tr_b16 v[88:89], v76 offset:40960
  ds_read_b64_tr_b16 v[90:91], v77 offset:40960
  v_add_u32_dpp v78, v120, v55 quad_perm:[1,1,1,1] row_mask:0xf bank_mask:0xf
  v_add_u32_dpp v79, v121, v55 quad_perm:[1,1,1,1] row_mask:0xf bank_mask:0xf
  ds_read_b64_tr_b16 v[92:93], v78 offset:0
  ds_read_b64_tr_b16 v[94:95], v79 offset:0
  ds_read_b64_tr_b16 v[96:97], v78 offset:40960
  ds_read_b64_tr_b16 v[98:99], v79 offset:40960
  v_add_u32_dpp v80, v120, v55 quad_perm:[2,2,2,2] row_mask:0xf bank_mask:0xf
  v_add_u32_dpp v81, v121, v55 quad_perm:[2,2,2,2] row_mask:0xf bank_mask:0xf
  ds_read_b64_tr_b16 v[100:101], v80 offset:0
  ds_read_b64_tr_b16 v[102:103], v81 offset:0
  ds_read_b64_tr_b16 v[104:105], v80 offset:40960
  ds_read_b64_tr_b16 v[106:107], v81 offset:40960
  v_add_u32_dpp v82, v120, v55 quad_perm:[3,3,3,3] row_mask:0xf bank_mask:0xf
  v_add_u32_dpp v83, v121, v55 quad_perm:[3,3,3,3] row_mask:0xf bank_mask:0xf
  ds_read_b64_tr_b16 v[108:109], v82 offset:0
  ds_read_b64_tr_b16 v[110:111], v83 offset:0
  ds_read_b64_tr_b16 v[112:113], v82 offset:40960
  ds_read_b64_tr_b16 v[114:115], v83 offset:40960
  v_lshlrev_b64 v[118:119], 1, v[34:35]
  v_pk_ashrrev_i16 v120, 15, v34 op_sel_hi:[0,1]
  v_pk_ashrrev_i16 v121, 15, v35 op_sel_hi:[0,1]
  v_pk_ashrrev_i16 v122, 15, v118 op_sel_hi:[0,1]
  v_pk_ashrrev_i16 v123, 15, v119 op_sel_hi:[0,1]
  v_and_b32_dpp v76, v33, v120 row_newbcast:0 row_mask:0xf bank_mask:0xf
  v_and_b32_dpp v77, v33, v121 row_newbcast:1 row_mask:0xf bank_mask:0xf
  v_and_b32_dpp v78, v33, v122 row_newbcast:2 row_mask:0xf bank_mask:0xf
  v_and_b32_dpp v79, v33, v123 row_newbcast:3 row_mask:0xf bank_mask:0xf
  v_lshlrev_b64 v[116:117], 2, v[34:35]
  v_lshlrev_b64 v[118:119], 3, v[34:35]
  v_pk_ashrrev_i16 v120, 15, v116 op_sel_hi:[0,1]
  v_pk_ashrrev_i16 v121, 15, v117 op_sel_hi:[0,1]
  v_pk_ashrrev_i16 v122, 15, v118 op_sel_hi:[0,1]
  s_waitcnt lgkmcnt(14)
  v_mfma_f32_16x16x32_bf16 v[12:15], v[84:87], v[76:79], v[12:15]
  v_pk_ashrrev_i16 v123, 15, v119 op_sel_hi:[0,1]
  v_and_b32_dpp v80, v33, v120 row_newbcast:4 row_mask:0xf bank_mask:0xf
  v_and_b32_dpp v81, v33, v121 row_newbcast:5 row_mask:0xf bank_mask:0xf
  v_and_b32_dpp v82, v33, v122 row_newbcast:6 row_mask:0xf bank_mask:0xf
  v_and_b32_dpp v83, v33, v123 row_newbcast:7 row_mask:0xf bank_mask:0xf
  s_waitcnt lgkmcnt(12)
  v_mfma_f32_16x16x32_bf16 v[16:19], v[88:91], v[76:79], v[16:19]
  v_lshlrev_b64 v[116:117], 4, v[34:35]
  v_lshlrev_b64 v[118:119], 5, v[34:35]
  v_pk_ashrrev_i16 v120, 15, v116 op_sel_hi:[0,1]
  v_pk_ashrrev_i16 v121, 15, v117 op_sel_hi:[0,1]
  v_pk_ashrrev_i16 v122, 15, v118 op_sel_hi:[0,1]
  s_waitcnt lgkmcnt(10)
  v_mfma_f32_16x16x32_bf16 v[12:15], v[92:95], v[80:83], v[12:15]
  v_pk_ashrrev_i16 v123, 15, v119 op_sel_hi:[0,1]
  v_and_b32_dpp v76, v33, v120 row_newbcast:8 row_mask:0xf bank_mask:0xf
  v_and_b32_dpp v77, v33, v121 row_newbcast:9 row_mask:0xf bank_mask:0xf
  v_and_b32_dpp v78, v33, v122 row_newbcast:10 row_mask:0xf bank_mask:0xf
  v_and_b32_dpp v79, v33, v123 row_newbcast:11 row_mask:0xf bank_mask:0xf
  s_waitcnt lgkmcnt(8)
  v_mfma_f32_16x16x32_bf16 v[16:19], v[96:99], v[80:83], v[16:19]
  v_lshlrev_b64 v[116:117], 6, v[34:35]
  v_lshlrev_b64 v[118:119], 7, v[34:35]
  v_pk_ashrrev_i16 v120, 15, v116 op_sel_hi:[0,1]
  v_pk_ashrrev_i16 v121, 15, v117 op_sel_hi:[0,1]
  v_pk_ashrrev_i16 v122, 15, v118 op_sel_hi:[0,1]
  s_waitcnt lgkmcnt(6)
  v_mfma_f32_16x16x32_bf16 v[12:15], v[100:103], v[76:79], v[12:15]
  v_pk_ashrrev_i16 v123, 15, v119 op_sel_hi:[0,1]
  v_and_b32_dpp v80, v33, v120 row_newbcast:12 row_mask:0xf bank_mask:0xf
  v_and_b32_dpp v81, v33, v121 row_newbcast:13 row_mask:0xf bank_mask:0xf
  v_and_b32_dpp v82, v33, v122 row_newbcast:14 row_mask:0xf bank_mask:0xf
  v_and_b32_dpp v83, v33, v123 row_newbcast:15 row_mask:0xf bank_mask:0xf
  s_waitcnt lgkmcnt(4)
  v_mfma_f32_16x16x32_bf16 v[16:19], v[104:107], v[76:79], v[16:19]
  s_waitcnt lgkmcnt(2)
  s_nop 0
  v_mfma_f32_16x16x32_bf16 v[12:15], v[108:111], v[80:83], v[12:15]
  s_waitcnt lgkmcnt(0)
  v_mfma_f32_16x16x32_bf16 v[16:19], v[112:115], v[80:83], v[16:19]
  s_sub_u32 s21, s21, 8
  s_cmp_lg_u32 s21, 0
  s_cbranch_scc1 L_moreb1
L_doneb1:
  s_add_u32 s26, s16, 18
  s_add_u32 s25, s17, 121344
  v_readlane_b32 s21, v63, s26
  buffer_load_dwordx3 v[32:34], v59, s[4:7], s25 offen
  s_cmp_le_u32 s21, 8
  s_cbranch_scc1 L_nfb1
  s_add_u32 s25, s25, 10223616
  buffer_load_dwordx3 v[56:58], v59, s[4:7], s25 offen
L_nfb1:
  s_add_u32 s16, s16, 1
  s_add_u32 s17, s17, 768
  v_xor_b32 v55, 0x14000, v55
  s_waitcnt vmcnt(2)
  s_barrier
  s_branch L_phase0
L_epi:
  v_and_b32 v71, 15, v67
  v_lshlrev_b32 v71, 9, v71
  v_lshrrev_b32 v2, 4, v67
  v_lshl_add_u32 v71, v2, 3, v71
  s_lshl_b32 s25, s28, 13
  s_lshl_b32 s3, s27, 6
  s_add_u32 s25, s25, s3
  s_nop 7
  v_cvt_pk_bf16_f32 v4, v4, v5
  v_cvt_pk_bf16_f32 v5, v6, v7
  buffer_store_dwordx2 v[4:5], v71, s[8:11], s25 offen offset:0
  v_cvt_pk_bf16_f32 v8, v8, v9
  v_cvt_pk_bf16_f32 v9, v10, v11
  buffer_store_dwordx2 v[8:9], v71, s[8:11], s25 offen offset:32
  s_add_u32 s25, s25, 98304
  v_cvt_pk_bf16_f32 v12, v12, v13
  v_cvt_pk_bf16_f32 v13, v14, v15
  buffer_store_dwordx2 v[12:13], v71, s[8:11], s25 offen offset:0
  v_cvt_pk_bf16_f32 v16, v16, v17
  v_cvt_pk_bf16_f32 v17, v18, v19
  buffer_store_dwordx2 v[16:17], v71, s[8:11], s25 offen offset:32
  s_add_u32 s25, s25, 98304
  s_cmp_ge_u32 s29, 8
  s_cbranch_scc1 L_fin
  v_cvt_pk_bf16_f32 v20, v20, v21
  v_cvt_pk_bf16_f32 v21, v22, v23
  buffer_store_dwordx2 v[20:21], v71, s[8:11], s25 offen offset:0
  v_cvt_pk_bf16_f32 v24, v24, v25
  v_cvt_pk_bf16_f32 v25, v26, v27
  buffer_store_dwordx2 v[24:25], v71, s[8:11], s25 offen offset:32
L_fin:
L_end:
  s_endpgm
.globl pre_kernel
.p2align 8
.type pre_kernel,@function
pre_kernel:
  s_cmp_ge_u32 s2, 1024
  s_cbranch_scc1 P_end
  s_load_dwordx4 s[4:7], s[0:1], 0
  s_load_dwordx2 s[8:9], s[0:1], 16
  s_load_dwordx2 s[10:11], s[0:1], 40
  v_lshrrev_b32 v2, 6, v0
  v_and_b32 v1, 63, v0
  v_readfirstlane_b32 s3, v2
  v_mov_b32 v6, 0
  v_mov_b32 v7, 0
  v_lshlrev_b32 v3, 3, v0
  ds_write_b64 v3, v[6:7]
  v_lshlrev_b32 v2, 4, v0
  s_mul_i32 s28, s2, 10432
  s_mul_i32 s29, s2, 5216
  s_add_u32 s30, s28, 4096
  s_add_u32 s31, s28, 8192
  s_add_u32 s56, s29, 4096
  v_cmp_gt_u32 vcc, 140, v0
  v_bfrev_b32 v5, 1
  s_nop 0
  v_cndmask_b32 v4, v5, v3, vcc
  v_cndmask_b32 v5, v5, v2, vcc
  s_waitcnt lgkmcnt(0)
  s_mov_b32 s12, s4
  s_mov_b32 s13, s5
  s_mov_b32 s14, 5341184
  s_mov_b32 s15, 0x20000
  s_mov_b32 s16, s6
  s_mov_b32 s17, s7
  s_mov_b32 s18, 10682368
  s_mov_b32 s19, 0x20000
  s_mov_b32 s20, s8
  s_mov_b32 s21, s9
  s_mov_b32 s22, 8388608
  s_mov_b32 s23, 0x20000
  s_mov_b32 s24, s10
  s_mov_b32 s25, s11
  s_mov_b32 s26, 268435456
  s_mov_b32 s27, 0x20000
  buffer_load_dwordx2 v[20:21], v3, s[12:15], s29 offen
  buffer_load_dwordx2 v[22:23], v3, s[12:15], s29 offen offset:2048
  buffer_load_dwordx2 v[24:25], v4, s[12:15], s56 offen
  v_mov_b32 v50, v2
  s_mov_b32 s62, s28
  s_mov_b32 s63, s30
  s_mov_b32 s64, s31
  v_lshrrev_b32 v2, 3, v1
  v_and_b32 v3, 7, v1
  v_lshlrev_b32 v60, 4, v3
  v_lshl_add_u32 v60, v2, 9, v60
  s_lshl_b32 s28, s2, 13
  s_lshl_b32 s29, s3, 7
  s_add_u32 s28, s28, s29
  s_add_u32 s29, s28, 4096
  s_mov_b32 s61, s28
  v_bfe_u32 v2, v1, 1, 4
  v_lshlrev_b32 v60, 9, v2
  v_lshrrev_b32 v2, 5, v1
  v_lshl_add_u32 v60, v2, 5, v60
  v_and_b32 v3, 1, v1
  v_lshl_add_u32 v60, v3, 4, v60
  v_lshlrev_b32 v87, 5, v2
  v_and_b32 v2, 1, v1
  v_lshl_add_u32 v87, v2, 4, v87
  s_mov_b32 s28, 40960
  s_mov_b32 s29, 1064960
  v_bfe_u32 v2, v1, 1, 1
  v_mad_u32_u24 v87, v2, s28, v87
  v_bfe_u32 v2, v1, 2, 1
  v_mad_u32_u24 v87, v2, s29, v87
  v_and_b32 v87, 31, v1
  v_lshlrev_b32 v87, 4, v87
  v_lshrrev_b32 v2, 5, v1
  v_mad_u32_u24 v87, v2, s28, v87
  s_add_u32 s29, s2, 16
  s_mul_i32 s28, s29, 13108
  s_lshr_b32 s28, s28, 20
  s_mul_i32 s28, s28, 40960
  s_lshl_b32 s29, s29, 9
  s_add_u32 s28, s28, s29
  s_mul_i32 s29, s3, 2129920
  s_add_u32 s28, s28, s29
  s_add_u32 s57, s28, 234881024
  v_mul_u32_u24 v4, 3293688, v0
  v_mov_b32 v5, 4
  s_mov_b32 s28, 4294966016
  s_mov_b32 s30, 0x05040100
  s_mov_b32 s31, 0x07060100
  s_barrier
  s_waitcnt vmcnt(2)
  v_cmp_neq_f16_sdwa s[32:33], v20, v6 src0_sel:WORD_0 src1_sel:DWORD
  v_cmp_neq_f16_sdwa s[34:35], v20, v6 src0_sel:WORD_1 src1_sel:DWORD
  v_cmp_neq_f16_sdwa s[36:37], v21, v6 src0_sel:WORD_0 src1_sel:DWORD
  v_cmp_neq_f16_sdwa s[38:39], v21, v6 src0_sel:WORD_1 src1_sel:DWORD
  s_or_b64 s[58:59], s[32:33], s[34:35]
  s_or_b64 exec, s[36:37], s[38:39]
  s_or_b64 exec, exec, s[58:59]
  buffer_load_dwordx4 v[8:11], v50, s[16:19], s62 offen
  s_mov_b64 exec, -1
  s_waitcnt vmcnt(2)
  v_cmp_neq_f16_sdwa s[40:41], v22, v6 src0_sel:WORD_0 src1_sel:DWORD
  v_cmp_neq_f16_sdwa s[42:43], v22, v6 src0_sel:WORD_1 src1_sel:DWORD
  v_cmp_neq_f16_sdwa s[44:45], v23, v6 src0_sel:WORD_0 src1_sel:DWORD
  v_cmp_neq_f16_sdwa s[46:47], v23, v6 src0_sel:WORD_1 src1_sel:DWORD
  s_or_b64 s[58:59], s[40:41], s[42:43]
  s_or_b64 exec, s[44:45], s[46:47]
  s_or_b64 exec, exec, s[58:59]
  buffer_load_dwordx4 v[12:15], v50, s[16:19], s63 offen
  s_mov_b64 exec, -1
  s_waitcnt vmcnt(2)
  v_cmp_neq_f16_sdwa s[48:49], v24, v6 src0_sel:WORD_0 src1_sel:DWORD
  v_cmp_neq_f16_sdwa s[50:51], v24, v6 src0_sel:WORD_1 src1_sel:DWORD
  v_cmp_neq_f16_sdwa s[52:53], v25, v6 src0_sel:WORD_0 src1_sel:DWORD
  v_cmp_neq_f16_sdwa s[54:55], v25, v6 src0_sel:WORD_1 src1_sel:DWORD
  s_or_b64 s[58:59], s[48:49], s[50:51]
  s_or_b64 exec, s[52:53], s[54:55]
  s_or_b64 exec, exec, s[58:59]
  buffer_load_dwordx4 v[16:19], v50, s[16:19], s64 offen
  s_mov_b64 exec, -1
  s_add_u32 s29, s61, 64
  buffer_load_dwordx4 v[88:91], v60, s[20:23], s61 offen
  buffer_load_dwordx4 v[92:95], v60, s[20:23], s29 offen
  s_waitcnt vmcnt(4)
  s_mov_b64 exec, s[32:33]
  v_add_u32 v8, 256, v8
  v_mul_hi_u32_u24 v2, 3355444, v8
  v_lshlrev_b32 v3, 29, v8
  v_alignbit_b32 v26, v2, v3, 27
  ds_add_rtn_u32 v38, v26, v5
  v_mad_i32_i24 v8, v2, s28, v8
  v_add_u32 v3, 0, v4
  v_alignbit_b32 v8, v8, v3, 27
  v_perm_b32 v8, v20, v8, s30
  s_mov_b64 exec, s[34:35]
  v_add_u32 v9, 256, v9
  v_mul_hi_u32_u24 v2, 3355444, v9
  v_lshlrev_b32 v3, 29, v9
  v_alignbit_b32 v27, v2, v3, 27
  ds_add_rtn_u32 v39, v27, v5
  v_mad_i32_i24 v9, v2, s28, v9
  v_add_u32 v3, 823422, v4
  v_alignbit_b32 v9, v9, v3, 27
  v_perm_b32 v9, v20, v9, s31
  s_mov_b64 exec, s[36:37]
  v_add_u32 v10, 256, v10
  v_mul_hi_u32_u24 v2, 3355444, v10
  v_lshlrev_b32 v3, 29, v10
  v_alignbit_b32 v28, v2, v3, 27
  ds_add_rtn_u32 v40, v28, v5
  v_mad_i32_i24 v10, v2, s28, v10
  v_add_u32 v3, 1646844, v4
  v_alignbit_b32 v10, v10, v3, 27
  v_perm_b32 v10, v21, v10, s30
  s_mov_b64 exec, s[38:39]
  v_add_u32 v11, 256, v11
  v_mul_hi_u32_u24 v2, 3355444, v11
  v_lshlrev_b32 v3, 29, v11
  v_alignbit_b32 v29, v2, v3, 27
  ds_add_rtn_u32 v41, v29, v5
  v_mad_i32_i24 v11, v2, s28, v11
  v_add_u32 v3, 2470266, v4
  v_alignbit_b32 v11, v11, v3, 27
  v_perm_b32 v11, v21, v11, s31
  s_mov_b64 exec, -1
  s_waitcnt vmcnt(3)
  s_mov_b64 exec, s[40:41]
  v_add_u32 v12, 256, v12
  v_mul_hi_u32_u24 v2, 3355444, v12
  v_lshlrev_b32 v3, 29, v12
  v_alignbit_b32 v30, v2, v3, 27
  ds_add_rtn_u32 v42, v30, v5
  v_mad_i32_i24 v12, v2, s28, v12
  v_add_u32 v3, 843184128, v4
  v_alignbit_b32 v12, v12, v3, 27
  v_perm_b32 v12, v22, v12, s30
  s_mov_b64 exec, s[42:43]
  v_add_u32 v13, 256, v13
  v_mul_hi_u32_u24 v2, 3355444, v13
  v_lshlrev_b32 v3, 29, v13
  v_alignbit_b32 v31, v2, v3, 27
  ds_add_rtn_u32 v43, v31, v5
  v_mad_i32_i24 v13, v2, s28, v13
  v_add_u32 v3, 844007550, v4
  v_alignbit_b32 v13, v13, v3, 27
  v_perm_b32 v13, v22, v13, s31
  s_mov_b64 exec, s[44:45]
  v_add_u32 v14, 256, v14
  v_mul_hi_u32_u24 v2, 3355444, v14
  v_lshlrev_b32 v3, 29, v14
  v_alignbit_b32 v32, v2, v3, 27
  ds_add_rtn_u32 v44, v32, v5
  v_mad_i32_i24 v14, v2, s28, v14
  v_add_u32 v3, 844830972, v4
  v_alignbit_b32 v14, v14, v3, 27
  v_perm_b32 v14, v23, v14, s30
  s_mov_b64 exec, s[46:47]
  v_add_u32 v15, 256, v15
  v_mul_hi_u32_u24 v2, 3355444, v15
  v_lshlrev_b32 v3, 29, v15
  v_alignbit_b32 v33, v2, v3, 27
  ds_add_rtn_u32 v45, v33, v5
  v_mad_i32_i24 v15, v2, s28, v15
  v_add_u32 v3, 845654394, v4
  v_alignbit_b32 v15, v15, v3, 27
  v_perm_b32 v15, v23, v15, s31
  s_mov_b64 exec, -1
  s_cmp_eq_u32 s3, 3
  s_cbranch_scc1 P_a3
  s_waitcnt vmcnt(2)
  s_mov_b64 exec, s[48:49]
  v_add_u32 v16, 256, v16
  v_mul_hi_u32_u24 v2, 3355444, v16
  v_lshlrev_b32 v3, 29, v16
  v_alignbit_b32 v34, v2, v3, 27
  ds_add_rtn_u32 v46, v34, v5
  v_mad_i32_i24 v16, v2, s28, v16
  v_add_u32 v3, 1686368256, v4
  v_alignbit_b32 v16, v16, v3, 27
  v_perm_b32 v16, v24, v16, s30
  s_mov_b64 exec, s[50:51]
  v_add_u32 v17, 256, v17
  v_mul_hi_u32_u24 v2, 3355444, v17
  v_lshlrev_b32 v3, 29, v17
  v_alignbit_b32 v35, v2, v3, 27
  ds_add_rtn_u32 v47, v35, v5
  v_mad_i32_i24 v17, v2, s28, v17
  v_add_u32 v3, 1687191678, v4
  v_alignbit_b32 v17, v17, v3, 27
  v_perm_b32 v17, v24, v17, s31
  s_mov_b64 exec, s[52:53]
  v_add_u32 v18, 256, v18
  v_mul_hi_u32_u24 v2, 3355444, v18
  v_lshlrev_b32 v3, 29, v18
  v_alignbit_b32 v36, v2, v3, 27
  ds_add_rtn_u32 v48, v36, v5
  v_mad_i32_i24 v18, v2, s28, v18
  v_add_u32 v3, 1688015100, v4
  v_alignbit_b32 v18, v18, v3, 27
  v_perm_b32 v18, v25, v18, s30
  s_mov_b64 exec, s[54:55]
  v_add_u32 v19, 256, v19
  v_mul_hi_u32_u24 v2, 3355444, v19
  v_lshlrev_b32 v3, 29, v19
  v_alignbit_b32 v37, v2, v3, 27
  ds_add_rtn_u32 v49, v37, v5
  v_mad_i32_i24 v19, v2, s28, v19
  v_add_u32 v3, 1688838522, v4
  v_alignbit_b32 v19, v19, v3, 27
  v_perm_b32 v19, v25, v19, s31
  s_mov_b64 exec, -1
P_a3:
  s_cmp_lg_u32 s3, 0
  s_waitcnt lgkmcnt(0)
  s_barrier
  s_cbranch_scc1 P_np
  v_lshlrev_b32 v2, 3, v1
  ds_read_b64 v[62:63], v2
  s_mov_b32 s58, 0x88888888
  s_mov_b32 s59, s58
  s_waitcnt lgkmcnt(0)
  v_add_u32 v64, v62, v63
  s_nop 1
  v_add_u32_dpp v65, v64, v64 quad_perm:[1,0,3,2] row_mask:0xf bank_mask:0xf
  s_nop 1
  v_add_u32_dpp v66, v65, v65 quad_perm:[2,3,0,1] row_mask:0xf bank_mask:0xf
  v_add_u32 v67, 63, v66
  v_and_b32 v67, 0xffffffc0, v67
  v_sub_u32 v65, v67, v66
  v_cndmask_b32 v65, 0, v65, s[58:59]
  v_add_u32 v64, v64, v65
  v_mov_b32 v65, v64
  s_nop 1
  v_add_u32_dpp v65, v65, v65 row_shr:1 row_mask:0xf bank_mask:0xf
  s_nop 1
  v_add_u32_dpp v65, v65, v65 row_shr:2 row_mask:0xf bank_mask:0xf
  s_nop 1
  v_add_u32_dpp v65, v65, v65 row_shr:4 row_mask:0xf bank_mask:0xf
  s_nop 1
  v_add_u32_dpp v65, v65, v65 row_shr:8 row_mask:0xf bank_mask:0xf
  s_nop 1
  v_add_u32_dpp v65, v65, v65 row_bcast:15 row_mask:0xa bank_mask:0xf
  s_nop 1
  v_add_u32_dpp v65, v65, v65 row_bcast:31 row_mask:0xc bank_mask:0xf
  v_sub_u32 v65, v65, v64
  v_add_u32 v64, 2816, v65
  v_add_u32 v65, v64, v62
  ds_write_b64 v2, v[64:65] offset:2048
  v_add_u32 v68, v64, v66
  v_mov_b32 v69, v64
  v_lshrrev_b32 v70, 3, v67
  v_lshrrev_b32 v67, 6, v67
  v_cvt_f32_u32 v65, v67
  v_rcp_f32 v65, v65
  v_mov_b32 v66, 0x43800000
  v_fma_f32 v65, v65, v66, 0.5
  v_cvt_u32_f32 v65, v65
  v_add_u32 v71, 1, v65
  v_lshlrev_b32 v2, 2, v1
  s_lshl_b32 s29, s2, 6
  s_add_u32 s29, s29, 251658240
  s_mov_b32 exec_lo, 0x11111111
  s_mov_b32 exec_hi, 0x11111111
  ds_write_b128 v2, v[68:71] offset:2560
  buffer_store_dword v67, v1, s[24:27], s29 offen
  s_mov_b64 exec, -1
  s_waitcnt lgkmcnt(0)
P_np:
  v_bfe_u32 v82, v1, 4, 1
  v_bfe_u32 v83, v1, 2, 2
  v_and_b32 v84, 3, v1
  v_lshl_add_u32 v70, v82, 2, v83
  v_and_b32 v72, 1, v1
  v_lshlrev_b32 v72, 1, v72
  v_lshl_add_u32 v72, v82, 2, v72
  v_lshrrev_b32 v82, 5, v1
  v_lshlrev_b32 v71, 3, v82
  v_lshl_add_u32 v73, v83, 4, v71
  v_lshl_add_u32 v71, v84, 4, v71
  v_bfe_u32 v74, v1, 1, 1
  v_lshl_add_u32 v73, v74, 2, v73
  v_lshlrev_b32 v81, 6, v82
  s_lshl_b32 s29, s3, 4
  v_add_u32 v81, s29, v81
  v_bfe_u32 v74, v1, 2, 1
  v_lshl_add_u32 v74, v74, 4, 15
  v_and_b32 v75, 8, v1
  v_sub_u32 v74, v74, v75
  v_lshlrev_b32 v84, 1, v84
  v_sub_u32 v74, v74, v84
  v_lshlrev_b32 v74, v74, 1
  v_lshrrev_b32 v75, 1, v74
  s_lshl_b32 s29, s3, 8
  s_add_u32 s29, s29, 512
  v_lshl_add_u32 v77, v1, 2, s29
  v_and_b32 v76, 0xffffffc0, v77
  v_mul_u32_u24 v78, 12, v1
  v_bfe_u32 v79, v1, 1, 3
  v_and_b32 v85, 3, v1
  v_lshlrev_b32 v85, 4, v85
  v_and_b32 v86, 12, v1
  v_lshlrev_b32 v86, 2, v86
  v_lshl_add_u32 v68, v82, 2, v85
  v_lshl_add_u32 v69, v82, 2, v86
  v_and_b32 v80, 31, v1
  v_lshlrev_b32 v80, 2, v80
  s_barrier
  ds_read_b128 v[20:23], v81 offset:2560
  ds_read_b128 v[64:67], v81 offset:2688
  s_mov_b64 exec, s[32:33]
  ds_read_b32 v52, v26 offset:2048
  s_mov_b64 exec, s[34:35]
  ds_read_b32 v53, v27 offset:2048
  s_mov_b64 exec, s[36:37]
  ds_read_b32 v54, v28 offset:2048
  s_mov_b64 exec, s[38:39]
  ds_read_b32 v55, v29 offset:2048
  s_mov_b64 exec, s[40:41]
  ds_read_b32 v56, v30 offset:2048
  s_mov_b64 exec, s[42:43]
  ds_read_b32 v57, v31 offset:2048
  s_mov_b64 exec, s[44:45]
  ds_read_b32 v58, v32 offset:2048
  s_mov_b64 exec, s[46:47]
  ds_read_b32 v59, v33 offset:2048
  s_cmp_eq_u32 s3, 3
  s_cbranch_scc1 P_b3
  s_mov_b64 exec, s[48:49]
  ds_read_b32 v60, v34 offset:2048
  s_mov_b64 exec, s[50:51]
  ds_read_b32 v61, v35 offset:2048
  s_mov_b64 exec, s[52:53]
  ds_read_b32 v62, v36 offset:2048
  s_mov_b64 exec, s[54:55]
  ds_read_b32 v63, v37 offset:2048
  s_waitcnt lgkmcnt(0)
  s_mov_b64 exec, s[48:49]
  v_add_u32 v60, v60, v46
  ds_write_b32 v60, v16
  s_mov_b64 exec, s[50:51]
  v_add_u32 v61, v61, v47
  ds_write_b32 v61, v17
  s_mov_b64 exec, s[52:53]
  v_add_u32 v62, v62, v48
  ds_write_b32 v62, v18
  s_mov_b64 exec, s[54:55]
  v_add_u32 v63, v63, v49
  ds_write_b32 v63, v19
P_b3:
  s_waitcnt lgkmcnt(0)
  s_mov_b64 exec, s[32:33]
  v_add_u32 v52, v52, v38
  ds_write_b32 v52, v8
  s_mov_b64 exec, s[34:35]
  v_add_u32 v53, v53, v39
  ds_write_b32 v53, v9
  s_mov_b64 exec, s[36:37]
  v_add_u32 v54, v54, v40
  ds_write_b32 v54, v10
  s_mov_b64 exec, s[38:39]
  v_add_u32 v55, v55, v41
  ds_write_b32 v55, v11
  s_mov_b64 exec, s[40:41]
  v_add_u32 v56, v56, v42
  ds_write_b32 v56, v12
  s_mov_b64 exec, s[42:43]
  v_add_u32 v57, v57, v43
  ds_write_b32 v57, v13
  s_mov_b64 exec, s[44:45]
  v_add_u32 v58, v58, v44
  ds_write_b32 v58, v14
  s_mov_b64 exec, s[46:47]
  v_add_u32 v59, v59, v45
  ds_write_b32 v59, v15
  s_mov_b64 exec, -1
  s_mov_b32 s28, 256
  v_mad_u32_u24 v23, v79, v23, s28
  v_lshrrev_b32 v23, 8, v23
  v_add_u32 v20, v20, v80
  v_mul_u32_u24 v23, v23, v22
  v_sub_u32 v23, v20, v23
  v_max_i32 v23, v23, v21
  v_lshl_add_u32 v16, v22, 3, v21
  v_cmp_lt_u32 s[32:33], v20, v16
  v_mad_u32_u24 v67, v79, v67, s28
  v_lshrrev_b32 v67, 8, v67
  v_add_u32 v64, v64, v80
  v_mul_u32_u24 v67, v67, v66
  v_sub_u32 v67, v64, v67
  v_max_i32 v67, v67, v65
  v_lshl_add_u32 v17, v66, 3, v65
  v_cmp_lt_u32 s[34:35], v64, v17
  v_readlane_b32 s40, v21, 0
  v_readlane_b32 s44, v22, 0
  v_readlane_b32 s41, v21, 32
  v_readlane_b32 s45, v22, 32
  v_readlane_b32 s42, v65, 0
  v_readlane_b32 s46, v66, 0
  v_readlane_b32 s43, v65, 32
  v_readlane_b32 s47, v66, 32
  s_mul_i32 s48, s2, 9984
  s_mul_i32 s29, s3, 768
  s_add_u32 s48, s48, s29
  s_mov_b32 s60, 0xffe0ffe0
  s_waitcnt lgkmcnt(0)
  s_barrier
  ds_read_u16 v16, v23
  ds_read_u16 v17, v67
  s_and_b32 s29, s44, -16
  v_cmp_eq_u32 vcc, s29, v85
  v_cmp_eq_u32 s[58:59], s29, v86
  s_nop 0
  v_cndmask_b32 v26, v71, v68, vcc
  v_cndmask_b32 v27, v73, v69, s[58:59]
  v_mad_u32_u24 v26, v70, s44, v26
  v_mad_u32_u24 v27, v72, s44, v27
  v_add_u32 v26, s40, v26
  v_add_u32 v27, s40, v27
  v_add_u32 v28, s44, v27
  s_and_b32 s29, s45, -16
  v_cmp_eq_u32 vcc, s29, v85
  v_cmp_eq_u32 s[58:59], s29, v86
  s_nop 0
  v_cndmask_b32 v29, v71, v68, vcc
  v_cndmask_b32 v30, v73, v69, s[58:59]
  v_mad_u32_u24 v29, v70, s45, v29
  v_mad_u32_u24 v30, v72, s45, v30
  v_add_u32 v29, s41, v29
  v_add_u32 v30, s41, v30
  v_add_u32 v31, s45, v30
  s_and_b32 s29, s46, -16
  v_cmp_eq_u32 vcc, s29, v85
  v_cmp_eq_u32 s[58:59], s29, v86
  s_nop 0
  v_cndmask_b32 v8, v71, v68, vcc
  v_cndmask_b32 v9, v73, v69, s[58:59]
  v_mad_u32_u24 v8, v70, s46, v8
  v_mad_u32_u24 v9, v72, s46, v9
  v_add_u32 v8, s42, v8
  v_add_u32 v9, s42, v9
  v_add_u32 v10, s46, v9
  s_and_b32 s29, s47, -16
  v_cmp_eq_u32 vcc, s29, v85
  v_cmp_eq_u32 s[58:59], s29, v86
  s_nop 0
  v_cndmask_b32 v11, v71, v68, vcc
  v_cndmask_b32 v12, v73, v69, s[58:59]
  v_mad_u32_u24 v11, v70, s47, v11
  v_mad_u32_u24 v12, v72, s47, v12
  v_add_u32 v11, s43, v11
  v_add_u32 v12, s43, v12
  v_add_u32 v13, s47, v12
  s_waitcnt lgkmcnt(0)
  s_mov_b64 exec, s[32:33]
  ds_write_b32 v20, v16
  s_mov_b64 exec, s[34:35]
  ds_write_b32 v64, v17
  s_mov_b64 exec, -1
  ds_read2_b32 v[32:33], v26 offset1:1
  ds_read_u16 v41, v27 offset:2
  ds_read_b32 v43, v28
  ds_read2_b32 v[34:35], v29 offset1:1
  ds_read_u16 v45, v30 offset:2
  ds_read_b32 v47, v31
  ds_read2_b32 v[36:37], v8 offset1:1
  ds_read_u16 v49, v9 offset:2
  ds_read_b32 v51, v10
  ds_read2_b32 v[38:39], v11 offset1:1
  ds_read_u16 v53, v12 offset:2
  ds_read_b32 v55, v13
  s_waitcnt lgkmcnt(9)
  v_and_b32 v82, 15, v32
  v_and_b32 v83, 15, v33
  v_lshl_add_u32 v82, v82, 2, v76
  v_lshl_add_u32 v83, v83, 2, v76
  ds_or_b32 v82, v74
  ds_or_b32 v83, v75
  ds_wrxchg_rtn_b32 v42, v77, v6
  v_perm_b32 v40, v33, v32, s30
  v_perm_b32 v41, v43, v41, s31
  v_and_b32 v40, s60, v40
  s_waitcnt lgkmcnt(9)
  v_and_b32 v82, 15, v34
  v_and_b32 v83, 15, v35
  v_lshl_add_u32 v82, v82, 2, v76
  v_lshl_add_u32 v83, v83, 2, v76
  ds_or_b32 v82, v74
  ds_or_b32 v83, v75
  ds_wrxchg_rtn_b32 v46, v77, v6
  v_perm_b32 v44, v35, v34, s30
  v_perm_b32 v45, v47, v45, s31
  v_and_b32 v44, s60, v44
  s_waitcnt lgkmcnt(9)
  v_and_b32 v82, 15, v36
  v_and_b32 v83, 15, v37
  v_lshl_add_u32 v82, v82, 2, v76
  v_lshl_add_u32 v83, v83, 2, v76
  ds_or_b32 v82, v74
  ds_or_b32 v83, v75
  ds_wrxchg_rtn_b32 v50, v77, v6
  v_perm_b32 v48, v37, v36, s30
  v_perm_b32 v49, v51, v49, s31
  v_and_b32 v48, s60, v48
  s_add_u32 s49, s48, 3072
  s_add_u32 s50, s48, 6144
  s_add_u32 s51, s48, 9216
  s_cmp_lg_u32 s3, 0
  s_cbranch_scc1 P_c3
  s_waitcnt lgkmcnt(9)
  v_and_b32 v82, 15, v38
  v_and_b32 v83, 15, v39
  v_lshl_add_u32 v82, v82, 2, v76
  v_lshl_add_u32 v83, v83, 2, v76
  ds_or_b32 v82, v74
  ds_or_b32 v83, v75
  ds_wrxchg_rtn_b32 v54, v77, v6
  v_perm_b32 v52, v39, v38, s30
  v_perm_b32 v53, v55, v53, s31
  v_and_b32 v52, s60, v52
P_c3:
  s_waitcnt vmcnt(0)
  buffer_store_dwordx4 v[88:91], v87, s[24:27], s57 offen sc1
  s_add_u32 s57, s57, 1064960
  buffer_store_dwordx4 v[92:95], v87, s[24:27], s57 offen sc1
  s_waitcnt lgkmcnt(0)
  buffer_store_dwordx3 v[40:42], v78, s[24:27], s48 offen sc1
  buffer_store_dwordx3 v[44:46], v78, s[24:27], s49 offen sc1
  buffer_store_dwordx3 v[48:50], v78, s[24:27], s50 offen sc1
  s_cmp_lg_u32 s3, 0
  s_cbranch_scc1 P_c4
  buffer_store_dwordx3 v[52:54], v78, s[24:27], s51 offen sc1
P_c4:
  s_min_u32 s28, s44, 1344
P_l0:
  s_cmp_le_u32 s28, 64
  s_cbranch_scc1 P_d0
  s_sub_u32 s28, s28, 64
  s_add_u32 s40, s40, 64
  s_and_b32 s29, s28, -16
  v_cmp_eq_u32 vcc, s29, v85
  v_cmp_eq_u32 s[58:59], s29, v86
  s_nop 0
  v_cndmask_b32 v26, v71, v68, vcc
  v_cndmask_b32 v27, v73, v69, s[58:59]
  v_mad_u32_u24 v26, v70, s44, v26
  v_mad_u32_u24 v27, v72, s44, v27
  v_add_u32 v26, s40, v26
  v_add_u32 v27, s40, v27
  v_add_u32 v28, s44, v27
  s_add_u32 s48, s48, 10223616
  s_waitcnt vmcnt(0)
  ds_read2_b32 v[32:33], v26 offset1:1
  ds_read_u16 v41, v27 offset:2
  ds_read_b32 v43, v28
  s_waitcnt lgkmcnt(0)
  v_and_b32 v82, 15, v32
  v_and_b32 v83, 15, v33
  v_lshl_add_u32 v82, v82, 2, v76
  v_lshl_add_u32 v83, v83, 2, v76
  ds_or_b32 v82, v74
  ds_or_b32 v83, v75
  ds_wrxchg_rtn_b32 v42, v77, v6
  v_perm_b32 v40, v33, v32, s30
  v_perm_b32 v41, v43, v41, s31
  v_and_b32 v40, s60, v40
  s_waitcnt lgkmcnt(0)
  buffer_store_dwordx3 v[40:42], v78, s[24:27], s48 offen sc1
  s_branch P_l0
P_d0:
  s_min_u32 s28, s45, 1344
P_l1:
  s_cmp_le_u32 s28, 64
  s_cbranch_scc1 P_d1
  s_sub_u32 s28, s28, 64
  s_add_u32 s41, s41, 64
  s_and_b32 s29, s28, -16
  v_cmp_eq_u32 vcc, s29, v85
  v_cmp_eq_u32 s[58:59], s29, v86
  s_nop 0
  v_cndmask_b32 v29, v71, v68, vcc
  v_cndmask_b32 v30, v73, v69, s[58:59]
  v_mad_u32_u24 v29, v70, s45, v29
  v_mad_u32_u24 v30, v72, s45, v30
  v_add_u32 v29, s41, v29
  v_add_u32 v30, s41, v30
  v_add_u32 v31, s45, v30
  s_add_u32 s49, s49, 10223616
  s_waitcnt vmcnt(0)
  ds_read2_b32 v[34:35], v29 offset1:1
  ds_read_u16 v45, v30 offset:2
  ds_read_b32 v47, v31
  s_waitcnt lgkmcnt(0)
  v_and_b32 v82, 15, v34
  v_and_b32 v83, 15, v35
  v_lshl_add_u32 v82, v82, 2, v76
  v_lshl_add_u32 v83, v83, 2, v76
  ds_or_b32 v82, v74
  ds_or_b32 v83, v75
  ds_wrxchg_rtn_b32 v46, v77, v6
  v_perm_b32 v44, v35, v34, s30
  v_perm_b32 v45, v47, v45, s31
  v_and_b32 v44, s60, v44
  s_waitcnt lgkmcnt(0)
  buffer_store_dwordx3 v[44:46], v78, s[24:27], s49 offen sc1
  s_branch P_l1
P_d1:
  s_min_u32 s28, s46, 1344
P_l2:
  s_cmp_le_u32 s28, 64
  s_cbranch_scc1 P_d2
  s_sub_u32 s28, s28, 64
  s_add_u32 s42, s42, 64
  s_and_b32 s29, s28, -16
  v_cmp_eq_u32 vcc, s29, v85
  v_cmp_eq_u32 s[58:59], s29, v86
  s_nop 0
  v_cndmask_b32 v8, v71, v68, vcc
  v_cndmask_b32 v9, v73, v69, s[58:59]
  v_mad_u32_u24 v8, v70, s46, v8
  v_mad_u32_u24 v9, v72, s46, v9
  v_add_u32 v8, s42, v8
  v_add_u32 v9, s42, v9
  v_add_u32 v10, s46, v9
  s_add_u32 s50, s50, 10223616
  s_waitcnt vmcnt(0)
  ds_read2_b32 v[36:37], v8 offset1:1
  ds_read_u16 v49, v9 offset:2
  ds_read_b32 v51, v10
  s_waitcnt lgkmcnt(0)
  v_and_b32 v82, 15, v36
  v_and_b32 v83, 15, v37
  v_lshl_add_u32 v82, v82, 2, v76
  v_lshl_add_u32 v83, v83, 2, v76
  ds_or_b32 v82, v74
  ds_or_b32 v83, v75
  ds_wrxchg_rtn_b32 v50, v77, v6
  v_perm_b32 v48, v37, v36, s30
  v_perm_b32 v49, v51, v49, s31
  v_and_b32 v48, s60, v48
  s_waitcnt lgkmcnt(0)
  buffer_store_dwordx3 v[48:50], v78, s[24:27], s50 offen sc1
  s_branch P_l2
P_d2:
  s_cmp_lg_u32 s3, 0
  s_cbranch_scc1 P_end
  s_min_u32 s28, s47, 1344
P_l3:
  s_cmp_le_u32 s28, 64
  s_cbranch_scc1 P_d3
  s_sub_u32 s28, s28, 64
  s_add_u32 s43, s43, 64
  s_and_b32 s29, s28, -16
  v_cmp_eq_u32 vcc, s29, v85
  v_cmp_eq_u32 s[58:59], s29, v86
  s_nop 0
  v_cndmask_b32 v11, v71, v68, vcc
  v_cndmask_b32 v12, v73, v69, s[58:59]
  v_mad_u32_u24 v11, v70, s47, v11
  v_mad_u32_u24 v12, v72, s47, v12
  v_add_u32 v11, s43, v11
  v_add_u32 v12, s43, v12
  v_add_u32 v13, s47, v12
  s_add_u32 s51, s51, 10223616
  s_waitcnt vmcnt(0)
  ds_read2_b32 v[38:39], v11 offset1:1
  ds_read_u16 v53, v12 offset:2
  ds_read_b32 v55, v13
  s_waitcnt lgkmcnt(0)
  v_and_b32 v82, 15, v38
  v_and_b32 v83, 15, v39
  v_lshl_add_u32 v82, v82, 2, v76
  v_lshl_add_u32 v83, v83, 2, v76
  ds_or_b32 v82, v74
  ds_or_b32 v83, v75
  ds_wrxchg_rtn_b32 v54, v77, v6
  v_perm_b32 v52, v39, v38, s30
  v_perm_b32 v53, v55, v53, s31
  v_and_b32 v52, s60, v52
  s_waitcnt lgkmcnt(0)
  buffer_store_dwordx3 v[52:54], v78, s[24:27], s51 offen sc1
  s_branch P_l3
P_d3:
P_end:
  s_endpgm
.section .rodata,"a"
.p2align 6
.amdhsa_kernel standalone__sparse_matmul_formats_ell__sparse_mat_kernel
  .amdhsa_next_free_vgpr 124
  .amdhsa_next_free_sgpr 80
  .amdhsa_accum_offset 124
  .amdhsa_group_segment_fixed_size 0
  .amdhsa_kernarg_size 48
  .amdhsa_user_sgpr_count 2
  .amdhsa_user_sgpr_kernarg_segment_ptr 1
  .amdhsa_system_sgpr_workgroup_id_x 1
.end_amdhsa_kernel
.p2align 6
.amdhsa_kernel pre_kernel
  .amdhsa_next_free_vgpr 96
  .amdhsa_next_free_sgpr 80
  .amdhsa_accum_offset 96
  .amdhsa_group_segment_fixed_size 0
  .amdhsa_kernarg_size 48
  .amdhsa_user_sgpr_count 2
  .amdhsa_user_sgpr_kernarg_segment_ptr 1
  .amdhsa_system_sgpr_workgroup_id_x 1
.end_amdhsa_kernel
```
